```python
import torch

def _softmax(x, axis=-1):
    return torch.softmax(x, dim=axis)

def _gelu(x):
    return torch.nn.functional.gelu(x, approximate='tanh')

def _silu(x):
    return torch.nn.functional.silu(x)

def _sigmoid(x):
    return torch.sigmoid(x)

def _layernorm(x, axis=-1, eps=1e-05):
    m = x.mean(dim=axis, keepdim=True)
    v = x.var(dim=axis, keepdim=True, unbiased=False)
    return (x - m) / torch.sqrt(v + eps)

def _scatter_add(tgt, idx, src, axis=0):
    return tgt.clone().index_add_(axis, idx, src)

def _segment_sum(src, seg, n):
    out = torch.zeros((n,) + src.shape[1:], dtype=src.dtype)
    return out.index_add_(0, seg, src)

def _pad(x, pw):
    flat = tuple((v for pair in reversed(pw) for v in pair))
    return torch.nn.functional.pad(x, flat)
kernel_name = 'adaLN_cond__spectral_gfnet__glu_gated_bilinear__prompt'

def setup_inputs():

    _w = lambda a: (lambda t: t.to(torch.bfloat16) if t.is_floating_point() else t)(torch.as_tensor(a))

    def _A_setup():
        B, S, D = (1, 2048, 512)
        Df = D // 2 + 1
        return {'x': _w((lambda *s: torch.randn(*s, dtype=torch.bfloat16) * 0.05)(B, S, D)), 'w_r': _w((lambda *s: torch.randn(*s, dtype=torch.bfloat16) * 3.2)(S, Df) * 0.02), 'w_i': _w((lambda *s: torch.randn(*s, dtype=torch.bfloat16) * 3.2)(S, Df) * 0.02)}
    _A_in = _A_setup()

    def _B_setup():
        B, S, D, F = (1, 2048, 512, 1376)
        return {'x': _w((lambda *s: torch.randn(*s, dtype=torch.bfloat16) * 0.05)(B, S, D)), 'w_gate': _w((lambda *s: torch.randn(*s, dtype=torch.bfloat16) * 0.4)(D, F) * D ** (-0.5)), 'w_up': _w((lambda *s: torch.randn(*s, dtype=torch.bfloat16) * 0.4)(D, F) * D ** (-0.5)), 'w_down': _w((lambda *s: torch.randn(*s, dtype=torch.bfloat16) * 0.4)(F, D) * F ** (-0.5))}
    _B_in = _B_setup()
    return {'A_x': _A_in['x'], 'A_w_r': _A_in['w_r'], 'A_w_i': _A_in['w_i'], 'B_x': _B_in['x'], 'B_w_gate': _B_in['w_gate'], 'B_w_up': _B_in['w_up'], 'B_w_down': _B_in['w_down'], 'c': _w((lambda *s: torch.randn(*s, dtype=torch.bfloat16) * 0.1)(1, 512) * 8.0), 'w_mod': _w((lambda *s: torch.randn(*s, dtype=torch.bfloat16) * 0.1)(512, 6 * 512) * 512 ** (-0.5) * 8.0)}

def reference(A_x, A_w_r, A_w_i, B_x, B_w_gate, B_w_up, B_w_down, c, w_mod):

    def _A_ref(x, w_r, w_i):
        B, S, D = x.shape
        X = (lambda x, axes=(-2, -1): torch.fft.rfft2(x.float(), dim=axes))(x, axes=(-2, -1))
        W = w_r + 1j * w_i
        X = X * W
        y = (lambda x, s, axes=(-2, -1): torch.fft.irfft2(x, s=s, dim=axes).to(torch.bfloat16))(X, (S, D), axes=(-2, -1))
        return y

    def _B_ref(x, w_gate, w_up, w_down):
        g = torch.einsum('bsd,df->bsf', x, w_gate)
        u = torch.einsum('bsd,df->bsf', x, w_up)
        h = g * u
        return torch.einsum('bsf,fd->bsd', h, w_down)
    x = A_x
    mod = (_silu(c) @ w_mod).reshape(c.shape[0], 6, 1, -1)
    sa, ca, ga, sb, cb, gb = (mod[:, 0].clone(), mod[:, 1].clone(), mod[:, 2].clone(), mod[:, 3].clone(), mod[:, 4].clone(), mod[:, 5].clone())
    h = _layernorm(x, axis=-1) * (1 + ca) + sa
    x = x + ga * _A_ref(h, A_w_r, A_w_i)
    h = _layernorm(x, axis=-1) * (1 + cb) + sb
    x = x + gb * _B_ref(h, B_w_gate, B_w_up, B_w_down)
    return x
```

```asm
; @launch kernel=k12_kernel grid=(398,1,1) block=(1024,1,1) lds=156736
; @launch kernel=k34_kernel grid=(256,1,1) block=(512,1,1) lds=149504
.amdgcn_target "amdgcn-amd-amdhsa--gfx950"
.text
.globl k12_kernel
.p2align 8
.type k12_kernel,@function
k12_kernel:
s_load_dwordx2 s[8:9], s[0:1], 0
s_load_dwordx4 s[4:7], s[0:1], 80
s_load_dwordx4 s[16:19], s[0:1], 56
s_cmp_ge_u32 s2, 128
s_cbranch_scc1 K12_H2
s_mov_b32 s10, 0x200000
s_mov_b32 s11, 0x00020000
s_and_b32 s20, s2, 3
s_bfe_u32 s21, s2, 0x30003
s_lshl_b32 s21, s21, 2
s_add_u32 s20, s20, s21
s_bfe_u32 s21, s2, 0x10002
s_lshr_b32 s23, s2, 6
s_lshl_b32 s22, s23, 1
s_add_u32 s21, s21, s22
s_lshl_b32 s22, s20, 10
v_lshrrev_b32 v4, 4, v0
s_lshl_b32 s23, s23, 5
v_xor_b32 v4, s23, v4
v_and_b32 v14, 15, v0
v_lshlrev_b32 v5, 15, v4
v_lshl_add_u32 v5, v14, 4, v5
s_lshl_b32 s24, s21, 8
s_add_u32 s24, s24, s22
s_xor_b32 s25, s24, 256
s_xor_b32 s26, s24, 512
s_xor_b32 s27, s24, 768
s_waitcnt lgkmcnt(0)
buffer_load_dwordx4 v[16:19], v5, s[8:11], s24 offen
buffer_load_dwordx4 v[20:23], v5, s[8:11], s25 offen
buffer_load_dwordx4 v[24:27], v5, s[8:11], s26 offen
buffer_load_dwordx4 v[28:31], v5, s[8:11], s27 offen
s_branch KA_BODY
K12_H2:
s_cmp_lt_u32 s2, 194
s_cbranch_scc1 KB_HEAD
s_cmp_ge_u32 s2, 258
s_cbranch_scc1 K12_OTHER
s_sub_u32 s21, s2, 194
s_add_u32 s40, s21, 128
s_and_b32 s20, s21, 15
s_lshr_b32 s41, s21, 4
s_add_u32 s22, s20, 24
s_cmp_eq_u32 s41, 2
s_cmov_b32 s20, s22
s_and_b32 s22, s20, 8
s_lshl_b32 s22, s22, 1
s_add_u32 s22, s22, s20
s_add_u32 s22, s22, 16
s_cmp_eq_u32 s41, 3
s_cmov_b32 s20, s22
s_lshl_b32 s21, s20, 7
s_mov_b32 s22, 0
s_cmp_eq_u32 s41, 1
s_cmov_b32 s22, 1572864
s_cselect_b32 s23, 512, 0
s_add_u32 s21, s21, s22
s_add_u32 s22, s21, 786432
v_and_b32 v1, 7, v0
v_lshrrev_b32 v12, 3, v0
v_mul_u32_u24 v13, 6144, v12
v_lshl_add_u32 v13, v1, 4, v13
v_lshlrev_b32 v6, 1, v12
s_mov_b32 s10, 1024
s_mov_b32 s11, 0x00020000
s_mov_b32 s46, 3145728
s_mov_b32 s47, 0x00020000
s_waitcnt lgkmcnt(0)
s_mov_b32 s8, s16
s_mov_b32 s9, s17
s_mov_b32 s44, s18
s_mov_b32 s45, s19
buffer_load_dwordx4 v[16:19], v13, s[44:47], s21 offen
buffer_load_dwordx4 v[20:23], v13, s[44:47], s22 offen
buffer_load_ushort v32, v6, s[8:11], s23 offen
buffer_load_ushort v33, v6, s[8:11], s23 offen offset:256
s_cmp_lt_u32 s41, 2
s_cbranch_scc1 KG_BN
s_branch KG_BW
KB_HEAD:
s_load_dwordx4 s[44:47], s[0:1], 8
v_lshrrev_b32 v1, 6, v0
v_and_b32 v2, 63, v0
v_lshlrev_b32 v3, 4, v2
v_readfirstlane_b32 s3, v1
s_mov_b32 s38, 256
s_mov_b32 s42, 0
s_mov_b32 s39, 0x00020000
s_mov_b32 s14, 0x2000000
s_mov_b32 s15, 0x00020000
s_waitcnt lgkmcnt(0)
s_mov_b32 s36, s4
s_mov_b32 s37, s5
s_mov_b32 s12, s6
s_mov_b32 s13, s7
s_sub_u32 s22, s2, 128
s_cmp_eq_u32 s22, s3
s_cbranch_scc0 KB_NT
s_cmp_eq_u32 s3, 0
s_cbranch_scc0 KB_NT
s_memrealtime s[60:61]
v_mov_b32 v60, 0
s_waitcnt lgkmcnt(0)
s_or_b32 s60, s60, 1
v_mov_b32 v61, s60
s_mov_b64 exec, 1
buffer_store_dword v61, v60, s[36:39], 0 offen sc1
s_mov_b64 exec, -1
KB_NT:
s_and_b32 s20, s22, 7
s_lshr_b32 s21, s22, 4
s_lshl_b32 s21, s21, 3
s_add_u32 s20, s20, s21
s_bfe_u32 s21, s22, 0x10003
s_and_b32 s23, s22, 1
s_cmp_ge_u32 s22, 64
s_cmov_b32 s20, 32
s_cmov_b32 s21, s23
s_getpc_b64 s[16:17]
s_add_u32 s16, s16, TAB_K2@rel32@lo+4
s_addc_u32 s17, s17, TAB_K2@rel32@hi+12
s_mov_b32 s18, 0x2000
s_mov_b32 s19, 0x00020000
v_and_b32 v4, 15, v2
v_lshrrev_b32 v5, 4, v2
s_lshl_b32 s23, s3, 10
s_lshl_b32 s22, s21, 12
s_add_u32 s22, s22, s23
s_mov_b32 m0, s23
s_cmp_lt_u32 s3, 4
s_cbranch_scc0 K2_T1
buffer_load_dwordx4 v3, s[16:19], s22 offen lds
K2_T1:
s_waitcnt lgkmcnt(0)
s_lshl_b32 s30, s21, 3
s_xor_b32 s30, s30, s3
s_cmp_ge_u32 s30, 8
s_cselect_b32 s56, s46, s44
s_cselect_b32 s57, s47, s45
s_mov_b32 s58, 1052672
s_mov_b32 s59, 0x00020000
s_and_b32 s31, s30, 3
s_lshl_b32 s31, s31, 9
s_add_u32 s31, s31, s20
s_mov_b32 s32, 64
s_bitcmp1_b32 s30, 2
s_cbranch_scc0 KB_PL
s_sub_u32 s31, 0x800, s31
s_mov_b32 s32, -64
KB_PL:
s_mul_i32 s33, s30, 4384
s_add_u32 s33, s33, 86528
s_and_b32 s34, s31, 0x7ff
s_mul_i32 s34, s34, 514
s_andn2_b32 s34, s34, 15
s_mov_b32 m0, s33
s_mov_b32 exec_hi, 3
s_add_u32 s31, s31, s32
buffer_load_dwordx4 v3, s[56:59], s34 offen lds
s_mov_b32 exec_hi, -1
s_add_u32 s33, s33, 548
s_and_b32 s34, s31, 0x7ff
s_mul_i32 s34, s34, 514
s_andn2_b32 s34, s34, 15
s_mov_b32 m0, s33
s_mov_b32 exec_hi, 3
s_add_u32 s31, s31, s32
buffer_load_dwordx4 v3, s[56:59], s34 offen lds
s_mov_b32 exec_hi, -1
s_add_u32 s33, s33, 548
s_and_b32 s34, s31, 0x7ff
s_mul_i32 s34, s34, 514
s_andn2_b32 s34, s34, 15
s_mov_b32 m0, s33
s_mov_b32 exec_hi, 3
s_add_u32 s31, s31, s32
buffer_load_dwordx4 v3, s[56:59], s34 offen lds
s_mov_b32 exec_hi, -1
s_add_u32 s33, s33, 548
s_cmp_ge_u32 s2, 136
s_cbranch_scc1 KB_W3
s_sub_u32 s27, s3, 4
s_cmp_ge_u32 s27, 4
s_cbranch_scc1 KB_W3
s_getpc_b64 s[48:49]
s_add_u32 s48, s48, k12_kernel@rel32@lo+4
s_addc_u32 s49, s49, k12_kernel@rel32@hi+12
s_mov_b32 s50, CODE_END-k12_kernel
s_mov_b32 s51, 0x00020000
s_lshl_b32 s27, s27, 13
s_cmp_lt_u32 s3, 7
s_cbranch_scc1 KB_W1
s_mov_b32 s27, 0
s_getpc_b64 s[48:49]
s_add_u32 s48, s48, TAB_G1@rel32@lo+4
s_addc_u32 s49, s49, TAB_G1@rel32@hi+12
s_mov_b32 s50, 0x2000
s_mov_b32 s51, 0x00020000
KB_W1:
buffer_load_dwordx4 v[84:87], v3, s[48:51], s27 offen offset:0
buffer_load_dwordx4 v[84:87], v3, s[48:51], s27 offen offset:1024
buffer_load_dwordx4 v[84:87], v3, s[48:51], s27 offen offset:2048
buffer_load_dwordx4 v[84:87], v3, s[48:51], s27 offen offset:3072
s_add_u32 s27, s27, 4096
buffer_load_dwordx4 v[84:87], v3, s[48:51], s27 offen offset:0
buffer_load_dwordx4 v[84:87], v3, s[48:51], s27 offen offset:1024
buffer_load_dwordx4 v[84:87], v3, s[48:51], s27 offen offset:2048
buffer_load_dwordx4 v[84:87], v3, s[48:51], s27 offen offset:3072
KB_W3:
v_lshrrev_b32 v14, 5, v0
v_and_b32 v15, 31, v0
v_lshlrev_b32 v6, 6, v15
v_add_u32 v6, s20, v6
v_mul_u32_u24 v6, v6, v14
v_and_b32 v6, 0x7ff, v6
v_cvt_f32_u32 v6, v6
v_mul_f32 v6, 0x3a000000, v6
v_cos_f32 v7, v6
v_sin_f32 v8, v6
v_lshrrev_b32 v9, 4, v15
v_lshrrev_b32 v10, 4, v14
v_and_b32 v11, 15, v15
v_and_b32 v12, 15, v14
v_cvt_pk_bf16_f32 v13, v7, v8
v_lshlrev_b32 v6, 11, v9
v_lshl_add_u32 v6, v10, 10, v6
v_lshl_add_u32 v6, v11, 4, v6
v_lshrrev_b32 v7, 2, v12
v_lshl_add_u32 v6, v7, 8, v6
v_and_b32 v7, 3, v12
v_lshl_add_u32 v6, v7, 2, v6
ds_write_b32 v6, v13 offset:4096
v_lshlrev_b32 v6, 11, v10
v_lshl_add_u32 v6, v9, 10, v6
v_lshl_add_u32 v6, v12, 4, v6
v_lshrrev_b32 v7, 2, v11
v_lshl_add_u32 v6, v7, 8, v6
v_and_b32 v7, 3, v11
v_lshl_add_u32 v6, v7, 2, v6
ds_write_b32 v6, v13 offset:8192
s_and_b32 s34, s31, 0x7ff
s_mul_i32 s34, s34, 514
s_andn2_b32 s34, s34, 15
s_mov_b32 m0, s33
s_mov_b32 exec_hi, 3
s_add_u32 s31, s31, s32
buffer_load_dwordx4 v3, s[56:59], s34 offen lds
s_mov_b32 exec_hi, -1
s_add_u32 s33, s33, 548
v_lshl_add_u32 v6, v4, 1, s21
v_lshl_add_u32 v7, v5, 7, s3
v_mul_u32_u24 v7, v7, v6
v_and_b32 v7, 0x1ff, v7
v_cvt_f32_u32 v7, v7
v_cvt_f32_u32 v6, v6
v_mul_f32 v7, 0x3b000000, v7
v_mul_f32 v6, 0x3d000000, v6
v_cos_f32 v40, v7
v_sin_f32 v48, v7
v_add_f32 v7, v7, v6
v_cos_f32 v41, v7
v_sin_f32 v49, v7
v_add_f32 v7, v7, v6
v_cos_f32 v42, v7
v_sin_f32 v50, v7
v_add_f32 v7, v7, v6
v_cos_f32 v43, v7
v_sin_f32 v51, v7
s_and_b32 s34, s31, 0x7ff
s_mul_i32 s34, s34, 514
s_andn2_b32 s34, s34, 15
s_mov_b32 m0, s33
s_mov_b32 exec_hi, 3
s_add_u32 s31, s31, s32
buffer_load_dwordx4 v3, s[56:59], s34 offen lds
s_mov_b32 exec_hi, -1
s_add_u32 s33, s33, 548
v_add_f32 v7, v7, v6
v_cos_f32 v44, v7
v_sin_f32 v52, v7
v_add_f32 v7, v7, v6
v_cos_f32 v45, v7
v_sin_f32 v53, v7
v_add_f32 v7, v7, v6
v_cos_f32 v46, v7
v_sin_f32 v54, v7
v_add_f32 v7, v7, v6
v_cos_f32 v47, v7
v_sin_f32 v55, v7
s_and_b32 s34, s31, 0x7ff
s_mul_i32 s34, s34, 514
s_andn2_b32 s34, s34, 15
s_mov_b32 m0, s33
s_mov_b32 exec_hi, 3
s_add_u32 s31, s31, s32
buffer_load_dwordx4 v3, s[56:59], s34 offen lds
s_mov_b32 exec_hi, -1
s_add_u32 s33, s33, 548
s_lshl_b32 s25, s3, 1
s_add_u32 s25, s25, s21
v_lshl_add_u32 v6, v5, 6, s25
v_mul_u32_u24 v6, v6, v4
v_cvt_f32_u32 v6, v6
v_cvt_f32_u32 v7, v4
v_mul_f32 v6, 0x3b000000, v6
v_mul_f32 v7, 0x3d800000, v7
v_add_f32 v8, v6, v7
v_fma_f32 v9, v7, 4.0, v6
v_fma_f32 v10, v7, 4.0, v8
v_fma_f32 v9, v7, 4.0, v9
v_fma_f32 v10, v7, 4.0, v10
v_cos_f32 v11, v6
v_sin_f32 v12, v6
s_nop 0
v_cvt_pk_bf16_f32 v24, v11, -v12
v_cos_f32 v11, v8
v_sin_f32 v12, v8
s_nop 0
v_cvt_pk_bf16_f32 v25, v11, -v12
v_cos_f32 v11, v9
v_sin_f32 v12, v9
s_nop 0
v_cvt_pk_bf16_f32 v26, v11, -v12
v_cos_f32 v11, v10
v_sin_f32 v12, v10
s_nop 0
v_cvt_pk_bf16_f32 v27, v11, -v12
s_and_b32 s34, s31, 0x7ff
s_mul_i32 s34, s34, 514
s_andn2_b32 s34, s34, 15
s_mov_b32 m0, s33
s_mov_b32 exec_hi, 3
s_add_u32 s31, s31, s32
buffer_load_dwordx4 v3, s[56:59], s34 offen lds
s_mov_b32 exec_hi, -1
s_add_u32 s33, s33, 548
v_mul_u32_u24 v6, 1032, v4
v_lshl_add_u32 v6, v5, 8, v6
s_lshl_b32 s25, s3, 3
s_add_u32 s25, s25, 20480
v_add_u32 v6, s25, v6
v_add_u32 v7, 16512, v6
v_add_u32 v8, 33024, v6
v_add_u32 v9, 49536, v6
s_lshl_b32 s25, s3, 7
v_lshlrev_b32 v11, 13, v5
v_lshl_add_u32 v11, v4, 2, v11
s_add_u32 s25, s25, 86528
v_add_u32 v11, s25, v11
v_lshlrev_b32 v12, 9, v5
v_lshl_add_u32 v12, v4, 2, v12
s_lshl_b32 s25, s3, 11
s_add_u32 s25, s25, 86528
v_add_u32 v12, s25, v12
v_mul_u32_u24 v13, 4352, v5
v_lshl_add_u32 v13, v4, 2, v13
s_lshl_b32 s25, s3, 6
s_add_u32 s25, s25, 20480
v_add_u32 v13, s25, v13
v_bfe_u32 v14, v2, 2, 1
v_mul_u32_u24 v14, 1088, v14
v_lshrrev_b32 v15, 5, v2
v_lshl_add_u32 v14, v15, 8, v14
v_bfe_u32 v10, v2, 3, 2
v_lshl_add_u32 v14, v10, 4, v14
v_and_b32 v10, 3, v2
v_lshl_add_u32 v14, v10, 2, v14
s_mul_i32 s25, s3, 2176
s_add_u32 s25, s25, 20480
v_add_u32 v14, s25, v14
s_cmp_eq_u32 s20, 0
s_cbranch_scc0 K2_T3
v_cvt_pk_bf16_f32 v56, v40, v41
v_cvt_pk_bf16_f32 v60, -v48, -v49
v_cvt_pk_bf16_f32 v57, v42, v43
v_cvt_pk_bf16_f32 v61, -v50, -v51
v_cvt_pk_bf16_f32 v58, v44, v45
v_cvt_pk_bf16_f32 v62, -v52, -v53
v_cvt_pk_bf16_f32 v59, v46, v47
v_cvt_pk_bf16_f32 v63, -v54, -v55
K2_T3:
s_and_b32 s34, s31, 0x7ff
s_mul_i32 s34, s34, 514
s_andn2_b32 s34, s34, 15
s_mov_b32 m0, s33
s_mov_b32 exec_hi, 3
s_add_u32 s31, s31, s32
buffer_load_dwordx4 v3, s[56:59], s34 offen lds
s_mov_b32 exec_hi, -1
s_add_u32 s33, s33, 548
s_mov_b64 exec, -1
s_lshl_b32 s25, s3, 2
s_lshl_b32 s26, s21, 1
s_add_u32 s25, s25, s26
v_mul_u32_u24 v104, 548, v4
v_lshlrev_b32 v105, 7, v5
v_add_u32 v106, v104, v105
s_lshl_b32 s53, s20, 1
s_sub_u32 s54, 0, s53
s_and_b32 s53, s53, 15
s_and_b32 s54, s54, 15
s_add_u32 s26, s25, 86528
s_add_u32 s26, s26, s53
v_add_u32 v0, s26, v106
v_sub_u32 v107, v104, v105
s_sub_u32 s26, 104512, s25
s_add_u32 s26, s26, s54
v_add_u32 v1, s26, v107
s_mov_b32 s52, s25
v_mov_b32 v32, 0
v_mov_b32 v28, 0
v_mov_b32 v33, 0
v_mov_b32 v29, 0
v_mov_b32 v34, 0
v_mov_b32 v30, 0
v_mov_b32 v35, 0
v_mov_b32 v31, 0
v_mov_b32 v36, 0
v_mov_b32 v124, 0
v_mov_b32 v37, 0
v_mov_b32 v125, 0
v_mov_b32 v38, 0
v_mov_b32 v126, 0
v_mov_b32 v39, 0
v_mov_b32 v127, 0
v_mov_b32 v103, 156672
s_cmp_eq_u32 s3, 0
s_cbranch_scc0 KB_T1
s_mov_b64 exec, 1
v_mov_b32 v104, 0
s_mov_b32 s61, 0x40000
TAG_B:
buffer_load_dword v105, v104, s[36:39], 0 offen sc1
s_sub_u32 s61, s61, 1
s_cmp_eq_u32 s61, 0
s_cbranch_scc1 TAGD_B
s_waitcnt vmcnt(0)
v_readfirstlane_b32 s62, v105
s_cmp_eq_u32 s62, 0
s_cbranch_scc1 TAG_B
TAGD_B:
v_mov_b32 v105, s62
ds_write2_b32 v103, v104, v105 offset0:0 offset1:1
s_mov_b64 exec, -1
KB_T1:
s_waitcnt vmcnt(0)
KB_T2:
s_waitcnt lgkmcnt(0)
s_barrier
ds_read_b32 v102, v103 offset:4
ds_read_u16_d16_hi v32, v0 offset:0
ds_read_u16_d16_hi v28, v0 offset:35072
ds_read_u16_d16_hi v33, v0 offset:64
ds_read_u16_d16_hi v29, v0 offset:35136
ds_read_u16_d16_hi v34, v1 offset:64
ds_read_u16_d16_hi v30, v1 offset:35136
ds_read_u16_d16_hi v35, v1 offset:0
ds_read_u16_d16_hi v31, v1 offset:35072
ds_read_u16_d16_hi v36, v0 offset:8768
ds_read_u16_d16_hi v124, v0 offset:43840
ds_read_u16_d16_hi v37, v0 offset:8832
ds_read_u16_d16_hi v125, v0 offset:43904
ds_read_u16_d16_hi v38, v1 offset:8832
ds_read_u16_d16_hi v126, v1 offset:43904
ds_read_u16_d16_hi v39, v1 offset:8768
ds_read_u16_d16_hi v127, v1 offset:43840
s_cmp_eq_u32 s52, 0
s_cbranch_scc0 KB_NOFIX
s_mov_b64 exec, 0xffff
v_mul_u32_u24 v10, 548, v4
v_add_u32 v10, 86528, v10
v_add_u32 v105, s53, v10
v_add_u32 v10, s54, v10
v_mov_b32 v76, 0
v_mov_b32 v77, 0
v_mov_b32 v78, 0
v_mov_b32 v79, 0
v_mov_b32 v80, 0
v_mov_b32 v81, 0
v_mov_b32 v82, 0
v_mov_b32 v83, 0
ds_read_u16_d16_hi v76, v10 offset:17536
ds_read_u16_d16_hi v77, v105 offset:512
ds_read_u16_d16_hi v78, v10 offset:52608
ds_read_u16_d16_hi v79, v105 offset:35584
ds_read_u16_d16_hi v80, v10 offset:26304
ds_read_u16_d16_hi v81, v105 offset:9280
ds_read_u16_d16_hi v82, v10 offset:61376
ds_read_u16_d16_hi v83, v105 offset:44352
s_waitcnt lgkmcnt(0)
v_add_f32 v32, v32, v76
v_sub_f32 v28, v28, v78
v_add_f32 v34, v34, v77
v_sub_f32 v30, v30, v79
v_mul_f32 v32, 0.5, v32
v_mul_f32 v28, 0.5, v28
v_mul_f32 v34, 0.5, v34
v_mul_f32 v30, 0.5, v30
v_add_f32 v36, v36, v80
v_sub_f32 v124, v124, v82
v_add_f32 v38, v38, v81
v_sub_f32 v126, v126, v83
v_mul_f32 v36, 0.5, v36
v_mul_f32 v124, 0.5, v124
v_mul_f32 v38, 0.5, v38
v_mul_f32 v126, 0.5, v126
s_mov_b64 exec, -1
KB_NOFIX:
s_and_b32 s24, s20, 31
s_lshl_b32 s25, s24, 16
s_lshl_b32 s26, s3, 13
s_add_u32 s25, s25, s26
s_add_u32 s25, s25, 0x100000
s_add_u32 s26, s25, 0x8000
s_cmp_eq_u32 s20, 32
s_cmov_b32 s25, s26
s_cmp_eq_u32 s24, 0
s_cselect_b32 s26, 4, 16
s_cmp_ge_u32 s3, s26
s_cmov_b32 s25, 0x40000000
s_mul_i32 s26, s3, 8256
s_add_u32 s26, s26, 20480
s_lshl_b32 s27, s3, 10
s_add_u32 s28, s27, 12288
v_lshlrev_b32 v10, 9, v5
s_lshl_b32 s29, s3, 2
s_add_u32 s29, s29, 12288
v_add_u32 v10, s29, v10
s_waitcnt lgkmcnt(0)
v_readfirstlane_b32 s62, v102
s_mov_b32 s43, 0x80008000
s_cmp_lt_u32 s3, 8
s_cbranch_scc1 KB_G0
s_cmp_eq_u32 s20, 0
s_cbranch_scc0 KB_G2
KB_G0:
s_xor_b32 s27, s3, 8
s_lshl_b32 s28, s27, 9
s_add_u32 s28, s28, 0x30000
s_add_u32 s29, s28, 8192
v_lshlrev_b32 v104, 3, v2
s_mov_b32 s61, 0x40000
KB_G1:
buffer_load_dwordx2 v[76:77], v104, s[12:15], s28 offen sc1
buffer_load_dwordx2 v[78:79], v104, s[12:15], s29 offen sc1
s_sub_u32 s61, s61, 1
s_cmp_eq_u32 s61, 0
s_cbranch_scc1 KB_G3
s_waitcnt vmcnt(0)
v_xor_b32 v77, s62, v77
v_xor_b32 v79, s62, v79
v_or_b32 v77, v77, v79
v_cmp_ne_u32 vcc, 0, v77
s_cbranch_vccnz KB_G1
KB_G3:
v_add_f32 v76, v76, v78
s_cmp_lt_u32 s3, 8
s_cselect_b32 s28, 1.0, 0
v_cvt_pk_bf16_f32 v76, v76, v76
v_lshlrev_b32 v76, 16, v76
v_add_f32 v76, s28, v76
v_cvt_pk_bf16_f32 v76, v76, v76
v_lshlrev_b32 v76, 16, v76
s_lshl_b32 s27, s27, 8
s_add_u32 s27, s27, 12288
v_lshl_add_u32 v104, v2, 2, s27
ds_write_b32 v104, v76
s_waitcnt lgkmcnt(0)
KB_G2:
s_cmp_eq_u32 s3, 8
s_cbranch_scc0 KB_NP
s_mov_b32 s61, 0x40000
s_sub_u32 s63, s2, 128
s_lshl_b32 s63, s63, 11
s_add_u32 s63, s63, 0x40000
v_lshlrev_b32 v104, 3, v2
s_and_b32 s63, s2, 7
s_lshl_b32 s63, s63, 13
s_add_u32 s63, s63, 0x40000
s_add_u32 s27, s63, 1024
v_lshlrev_b32 v104, 4, v2
GL_M:
buffer_load_dword v106, v104, s[12:15], s63 offen sc1
buffer_load_dword v107, v104, s[12:15], s27 offen sc1
s_sub_u32 s61, s61, 1
s_cmp_eq_u32 s61, 0
s_cbranch_scc1 GD_C
s_waitcnt vmcnt(0)
v_xor_b32 v106, s62, v106
v_xor_b32 v107, s62, v107
v_or_b32 v106, v106, v107
v_cmp_ne_u32 vcc, 0, v106
s_cbranch_vccnz GL_M
GD_C:
ds_write_b32 v103, v103
KB_NP:
s_cmp_lt_u32 s3, 8
s_cbranch_scc0 K2_T7
s_mov_b32 s61, 0x400000
KB_SP:
ds_read_b32 v105, v103
s_sub_u32 s61, s61, 1
s_cmp_eq_u32 s61, 0
s_cbranch_scc1 KB_GO
s_waitcnt lgkmcnt(0)
v_cmp_eq_u32 vcc, 0, v105
s_cbranch_vccz KB_GO
s_sleep 1
s_branch KB_SP
KB_GO:
s_mov_b32 m0, s26
s_add_u32 s26, s26, 1032
buffer_load_dwordx4 v3, s[12:15], s25 offen sc1 lds
s_add_u32 s25, s25, 1024
s_mov_b32 m0, s26
s_add_u32 s26, s26, 1032
buffer_load_dwordx4 v3, s[12:15], s25 offen sc1 lds
s_add_u32 s25, s25, 1024
s_mov_b32 m0, s26
s_add_u32 s26, s26, 1032
buffer_load_dwordx4 v3, s[12:15], s25 offen sc1 lds
s_add_u32 s25, s25, 1024
s_mov_b32 m0, s26
s_add_u32 s26, s26, 1032
buffer_load_dwordx4 v3, s[12:15], s25 offen sc1 lds
s_add_u32 s25, s25, 1024
s_mov_b32 m0, s26
s_add_u32 s26, s26, 1032
buffer_load_dwordx4 v3, s[12:15], s25 offen sc1 lds
s_add_u32 s25, s25, 1024
s_mov_b32 m0, s26
s_add_u32 s26, s26, 1032
buffer_load_dwordx4 v3, s[12:15], s25 offen sc1 lds
s_add_u32 s25, s25, 1024
s_mov_b32 m0, s26
s_add_u32 s26, s26, 1032
buffer_load_dwordx4 v3, s[12:15], s25 offen sc1 lds
s_add_u32 s25, s25, 1024
s_mov_b32 m0, s26
s_add_u32 s26, s26, 1032
buffer_load_dwordx4 v3, s[12:15], s25 offen sc1 lds
s_add_u32 s25, s25, 1024
K2_T7:
s_barrier
v_add_u32 v100, 2048, v10
ds_read2_b32 v[92:93], v100 offset0:0 offset1:16
ds_read2_b32 v[94:95], v100 offset0:32 offset1:48
ds_read2_b32 v[96:97], v100 offset0:64 offset1:80
ds_read2_b32 v[98:99], v100 offset0:96 offset1:112
s_cmp_eq_u32 s20, 0
s_cbranch_scc0 K2_T4
ds_read2_b32 v[76:77], v10 offset0:0 offset1:16
ds_read2_b32 v[78:79], v10 offset0:32 offset1:48
ds_read2_b32 v[80:81], v10 offset0:64 offset1:80
ds_read2_b32 v[82:83], v10 offset0:96 offset1:112
s_waitcnt lgkmcnt(0)
v_mul_f32 v76, 0x42800000, v76
v_mul_f32 v77, 0x42800000, v77
v_mul_f32 v78, 0x42800000, v78
v_mul_f32 v79, 0x42800000, v79
v_mul_f32 v80, 0x42800000, v80
v_mul_f32 v81, 0x42800000, v81
v_mul_f32 v82, 0x42800000, v82
v_mul_f32 v83, 0x42800000, v83
v_cvt_pk_bf16_f32 v72, v76, v77
v_cvt_pk_bf16_f32 v73, v78, v79
v_cvt_pk_bf16_f32 v74, v80, v81
v_cvt_pk_bf16_f32 v75, v82, v83
K2_T4:
s_waitcnt lgkmcnt(0)
v_mul_f32 v40, v40, v92
v_mul_f32 v41, v41, v93
v_mul_f32 v42, v42, v94
v_mul_f32 v43, v43, v95
v_mul_f32 v44, v44, v96
v_mul_f32 v45, v45, v97
v_mul_f32 v46, v46, v98
v_mul_f32 v47, v47, v99
v_cvt_pk_bf16_f32 v112, v40, v41
v_cvt_pk_bf16_f32 v113, v42, v43
v_cvt_pk_bf16_f32 v114, v44, v45
v_cvt_pk_bf16_f32 v115, v46, v47
v_mul_f32 v48, v48, v92
v_mul_f32 v49, v49, v93
v_mul_f32 v50, v50, v94
v_mul_f32 v51, v51, v95
v_mul_f32 v52, v52, v96
v_mul_f32 v53, v53, v97
v_mul_f32 v54, v54, v98
v_mul_f32 v55, v55, v99
v_cvt_pk_bf16_f32 v116, v48, v49
v_cvt_pk_bf16_f32 v117, v50, v51
v_cvt_pk_bf16_f32 v118, v52, v53
v_cvt_pk_bf16_f32 v119, v54, v55
v_xor_b32 v120, s43, v116
v_xor_b32 v121, s43, v117
v_xor_b32 v122, s43, v118
v_xor_b32 v123, s43, v119
ds_read_b128 v[40:43], v3 offset:4096
ds_read_b128 v[44:47], v3 offset:5120
ds_read_b128 v[48:51], v3 offset:6144
ds_read_b128 v[52:55], v3 offset:7168
ds_read_b128 v[16:19], v3 offset:0
ds_read_b128 v[20:23], v3 offset:1024
v_lshlrev_b32 v10, 4, v4
v_lshl_add_u32 v10, v15, 16, v10
v_bfe_u32 v100, v2, 4, 1
s_movk_i32 s30, 512
s_cmp_eq_u32 s24, 0
s_cmov_b32 s30, 0x40000000
v_mul_lo_u32 v100, v100, s30
v_add_u32 v10, v10, v100
s_lshl_b32 s30, s24, 10
s_cmp_eq_u32 s20, 32
s_cmov_b32 s30, 512
s_lshl_b32 s31, s21, 15
s_add_u32 s30, s30, s31
s_lshl_b32 s31, s3, 17
s_add_u32 s30, s30, s31
s_add_u32 s30, s30, 0x600000
s_cmp_lt_u32 s3, 8
s_cbranch_scc0 K2_T6
s_waitcnt vmcnt(0)
K2_T6:
s_waitcnt lgkmcnt(0)
s_barrier
ds_read2_b64 v[76:79], v6 offset0:0 offset1:16
ds_read2_b64 v[80:83], v7 offset0:0 offset1:16
ds_read2_b64 v[84:87], v8 offset0:0 offset1:16
ds_read2_b64 v[88:91], v9 offset0:0 offset1:16
s_waitcnt lgkmcnt(3)
v_mfma_f32_16x16x32_bf16 v[92:95], v[76:79], v[112:115], 0
v_mfma_f32_16x16x32_bf16 v[96:99], v[76:79], v[120:123], 0
s_waitcnt lgkmcnt(2)
v_mfma_f32_16x16x32_bf16 v[100:103], v[80:83], v[112:115], 0
v_mfma_f32_16x16x32_bf16 v[104:107], v[80:83], v[120:123], 0
s_waitcnt lgkmcnt(1)
v_mfma_f32_16x16x32_bf16 v[92:95], v[84:87], v[116:119], v[92:95]
v_mfma_f32_16x16x32_bf16 v[96:99], v[84:87], v[112:115], v[96:99]
s_waitcnt lgkmcnt(0)
v_mfma_f32_16x16x32_bf16 v[100:103], v[88:91], v[116:119], v[100:103]
v_mfma_f32_16x16x32_bf16 v[104:107], v[88:91], v[112:115], v[104:107]
s_cmp_eq_u32 s20, 0
s_cbranch_scc0 K2_NOSA
v_mfma_f32_16x16x32_bf16 v[92:95], v[72:75], v[56:59], v[92:95]
v_mfma_f32_16x16x32_bf16 v[96:99], v[72:75], v[60:63], v[96:99]
v_mfma_f32_16x16x32_bf16 v[100:103], v[72:75], v[56:59], v[100:103]
v_mfma_f32_16x16x32_bf16 v[104:107], v[72:75], v[60:63], v[104:107]
K2_NOSA:
s_nop 2
s_nop 2
v_cvt_pk_bf16_f32 v108, v92, v96
v_cvt_pk_bf16_f32 v116, v96, -v92
v_cvt_pk_bf16_f32 v109, v93, v97
v_cvt_pk_bf16_f32 v117, v97, -v93
v_cvt_pk_bf16_f32 v110, v94, v98
v_cvt_pk_bf16_f32 v118, v98, -v94
v_cvt_pk_bf16_f32 v111, v95, v99
v_cvt_pk_bf16_f32 v119, v99, -v95
v_cvt_pk_bf16_f32 v112, v100, v104
v_cvt_pk_bf16_f32 v120, v104, -v100
v_cvt_pk_bf16_f32 v113, v101, v105
v_cvt_pk_bf16_f32 v121, v105, -v101
v_cvt_pk_bf16_f32 v114, v102, v106
v_cvt_pk_bf16_f32 v122, v106, -v102
v_cvt_pk_bf16_f32 v115, v103, v107
v_cvt_pk_bf16_f32 v123, v107, -v103
s_waitcnt lgkmcnt(0)
v_mfma_f32_16x16x32_bf16 v[92:95], v[108:111], v[40:43], 0
v_mfma_f32_16x16x32_bf16 v[96:99], v[116:119], v[40:43], 0
v_mfma_f32_16x16x32_bf16 v[100:103], v[108:111], v[48:51], 0
v_mfma_f32_16x16x32_bf16 v[104:107], v[116:119], v[48:51], 0
v_mfma_f32_16x16x32_bf16 v[92:95], v[112:115], v[44:47], v[92:95]
v_mfma_f32_16x16x32_bf16 v[96:99], v[120:123], v[44:47], v[96:99]
v_mfma_f32_16x16x32_bf16 v[100:103], v[112:115], v[52:55], v[100:103]
v_mfma_f32_16x16x32_bf16 v[104:107], v[120:123], v[52:55], v[104:107]
ds_read_b128 v[56:59], v3 offset:8192
ds_read_b128 v[60:63], v3 offset:9216
ds_read_b128 v[64:67], v3 offset:10240
ds_read_b128 v[68:71], v3 offset:11264
s_nop 1
v_cvt_pk_bf16_f32 v76, v92, v96
ds_write_b32 v11, v76 offset:0
v_cvt_pk_bf16_f32 v77, v93, v97
ds_write_b32 v11, v77 offset:2048
v_cvt_pk_bf16_f32 v78, v94, v98
ds_write_b32 v11, v78 offset:4096
v_cvt_pk_bf16_f32 v79, v95, v99
ds_write_b32 v11, v79 offset:6144
v_cvt_pk_bf16_f32 v80, v100, v104
ds_write_b32 v11, v80 offset:64
v_cvt_pk_bf16_f32 v81, v101, v105
ds_write_b32 v11, v81 offset:2112
v_cvt_pk_bf16_f32 v82, v102, v106
ds_write_b32 v11, v82 offset:4160
v_cvt_pk_bf16_f32 v83, v103, v107
ds_write_b32 v11, v83 offset:6208
s_waitcnt lgkmcnt(0)
s_barrier
ds_read2_b32 v[108:109], v12 offset0:0 offset1:32
ds_read2_b32 v[110:111], v12 offset0:64 offset1:96
ds_read2_b32 v[112:113], v12 offset0:16 offset1:48
ds_read2_b32 v[114:115], v12 offset0:80 offset1:112
s_waitcnt lgkmcnt(2)
v_mfma_f32_16x16x32_bf16 v[92:95], v[16:19], v[108:111], 0
v_mfma_f32_16x16x32_bf16 v[96:99], v[20:23], v[108:111], 0
s_waitcnt lgkmcnt(0)
v_mfma_f32_16x16x32_bf16 v[100:103], v[16:19], v[112:115], 0
v_mfma_f32_16x16x32_bf16 v[104:107], v[20:23], v[112:115], 0
ds_read_b128 v[40:43], v3 offset:2048
ds_read_b128 v[44:47], v3 offset:3072
s_nop 1
v_mul_f32 v72, v92, v32
v_mul_f32 v73, v93, v32
v_fma_f32 v72, -v93, v28, v72
v_fma_f32 v73, v92, v28, v73
v_cvt_pk_bf16_f32 v76, v72, v73
v_cvt_pk_bf16_f32 v84, -v73, v72
v_mul_f32 v74, v94, v33
v_mul_f32 v75, v95, v33
v_fma_f32 v74, -v95, v29, v74
v_fma_f32 v75, v94, v29, v75
v_cvt_pk_bf16_f32 v77, v74, v75
v_cvt_pk_bf16_f32 v85, -v75, v74
v_mul_f32 v72, v96, v34
v_mul_f32 v73, v97, v34
v_fma_f32 v72, v97, v30, v72
v_fma_f32 v73, -v96, v30, v73
v_cvt_pk_bf16_f32 v78, v72, v73
v_cvt_pk_bf16_f32 v86, -v73, v72
v_mul_f32 v74, v98, v35
v_mul_f32 v75, v99, v35
v_fma_f32 v74, v99, v31, v74
v_fma_f32 v75, -v98, v31, v75
v_cvt_pk_bf16_f32 v79, v74, v75
v_cvt_pk_bf16_f32 v87, -v75, v74
s_nop 0
v_mfma_f32_16x16x32_bf16 v[92:95], v[76:79], v[24:27], 0
v_mfma_f32_16x16x32_bf16 v[96:99], v[84:87], v[24:27], 0
v_mul_f32 v72, v100, v36
v_mul_f32 v73, v101, v36
v_fma_f32 v72, -v101, v124, v72
v_fma_f32 v73, v100, v124, v73
v_cvt_pk_bf16_f32 v80, v72, v73
v_cvt_pk_bf16_f32 v88, -v73, v72
v_mul_f32 v74, v102, v37
v_mul_f32 v75, v103, v37
v_fma_f32 v74, -v103, v125, v74
v_fma_f32 v75, v102, v125, v75
v_cvt_pk_bf16_f32 v81, v74, v75
v_cvt_pk_bf16_f32 v89, -v75, v74
v_mul_f32 v72, v104, v38
v_mul_f32 v73, v105, v38
v_fma_f32 v72, v105, v126, v72
v_fma_f32 v73, -v104, v126, v73
v_cvt_pk_bf16_f32 v82, v72, v73
v_cvt_pk_bf16_f32 v90, -v73, v72
v_mul_f32 v74, v106, v39
v_mul_f32 v75, v107, v39
v_fma_f32 v74, v107, v127, v74
v_fma_f32 v75, -v106, v127, v75
v_cvt_pk_bf16_f32 v83, v74, v75
v_cvt_pk_bf16_f32 v91, -v75, v74
s_nop 0
v_mfma_f32_16x16x32_bf16 v[100:103], v[80:83], v[24:27], 0
v_mfma_f32_16x16x32_bf16 v[104:107], v[88:91], v[24:27], 0
s_nop 3
v_cvt_pk_bf16_f32 v108, v92, v96
v_cvt_pk_bf16_f32 v116, v96, -v92
v_cvt_pk_bf16_f32 v109, v93, v97
v_cvt_pk_bf16_f32 v117, v97, -v93
v_cvt_pk_bf16_f32 v110, v94, v98
v_cvt_pk_bf16_f32 v118, v98, -v94
v_cvt_pk_bf16_f32 v111, v95, v99
v_cvt_pk_bf16_f32 v119, v99, -v95
v_cvt_pk_bf16_f32 v112, v100, v104
v_cvt_pk_bf16_f32 v120, v104, -v100
v_cvt_pk_bf16_f32 v113, v101, v105
v_cvt_pk_bf16_f32 v121, v105, -v101
v_cvt_pk_bf16_f32 v114, v102, v106
v_cvt_pk_bf16_f32 v122, v106, -v102
v_cvt_pk_bf16_f32 v115, v103, v107
v_cvt_pk_bf16_f32 v123, v107, -v103
v_mfma_f32_16x16x32_bf16 v[92:95], v[56:59], v[108:111], 0
v_mfma_f32_16x16x32_bf16 v[96:99], v[56:59], v[116:119], 0
v_mfma_f32_16x16x32_bf16 v[100:103], v[64:67], v[108:111], 0
v_mfma_f32_16x16x32_bf16 v[104:107], v[64:67], v[116:119], 0
v_mfma_f32_16x16x32_bf16 v[92:95], v[60:63], v[112:115], v[92:95]
v_mfma_f32_16x16x32_bf16 v[96:99], v[60:63], v[120:123], v[96:99]
v_mfma_f32_16x16x32_bf16 v[100:103], v[68:71], v[112:115], v[100:103]
v_mfma_f32_16x16x32_bf16 v[104:107], v[68:71], v[120:123], v[104:107]
s_nop 5
v_cvt_pk_bf16_f32 v76, v92, v96
ds_write_b32 v13, v76 offset:0
v_cvt_pk_bf16_f32 v77, v93, v97
ds_write_b32 v13, v77 offset:1088
v_cvt_pk_bf16_f32 v78, v94, v98
ds_write_b32 v13, v78 offset:2176
v_cvt_pk_bf16_f32 v79, v95, v99
ds_write_b32 v13, v79 offset:3264
v_cvt_pk_bf16_f32 v80, v100, v104
ds_write_b32 v13, v80 offset:17408
v_cvt_pk_bf16_f32 v81, v101, v105
ds_write_b32 v13, v81 offset:18496
v_cvt_pk_bf16_f32 v82, v102, v106
ds_write_b32 v13, v82 offset:19584
v_cvt_pk_bf16_f32 v83, v103, v107
ds_write_b32 v13, v83 offset:20672
s_waitcnt lgkmcnt(0)
s_barrier
ds_read2_b32 v[108:109], v14 offset0:0 offset1:16
ds_read2_b32 v[110:111], v14 offset0:32 offset1:48
ds_read2_b32 v[112:113], v14 offset0:128 offset1:144
ds_read2_b32 v[114:115], v14 offset0:160 offset1:176
s_waitcnt lgkmcnt(2)
v_mfma_f32_32x32x16_bf16 v[92:107], v[108:111], v[40:43], 0
s_waitcnt lgkmcnt(0)
v_mfma_f32_32x32x16_bf16 v[92:107], v[112:115], v[44:47], v[92:107]
s_nop 11
v_cvt_pk_bf16_f32 v76, v92, v93
v_cvt_pk_bf16_f32 v77, v94, v95
v_cvt_pk_bf16_f32 v78, v96, v97
v_cvt_pk_bf16_f32 v79, v98, v99
buffer_store_dwordx4 v[76:79], v10, s[12:15], s30 offen offset:0 sc1
v_cvt_pk_bf16_f32 v80, v100, v101
v_cvt_pk_bf16_f32 v81, v102, v103
v_cvt_pk_bf16_f32 v82, v104, v105
v_cvt_pk_bf16_f32 v83, v106, v107
buffer_store_dwordx4 v[80:83], v10, s[12:15], s30 offen offset:256 sc1
s_endpgm
KA_BODY:
v_lshrrev_b32 v1, 6, v0
v_and_b32 v2, 63, v0
v_lshlrev_b32 v3, 4, v2
v_readfirstlane_b32 s3, v1
s_mov_b32 s38, 256
s_mov_b32 s42, 0
s_mov_b32 s39, 0x00020000
s_mov_b32 s14, 0x2000000
s_mov_b32 s15, 0x00020000
s_mov_b32 s36, s4
s_mov_b32 s37, s5
s_mov_b32 s12, s6
s_mov_b32 s13, s7
s_getpc_b64 s[16:17]
s_add_u32 s16, s16, TAB_F1@rel32@lo+4
s_addc_u32 s17, s17, TAB_F1@rel32@hi+12
s_mov_b32 s18, 0x2000
s_mov_b32 s19, 0x00020000
s_and_b32 s28, s3, 3
s_lshl_b32 s29, s28, 11
v_mul_u32_u24 v6, 288, v4
v_lshl_add_u32 v6, v14, 4, v6
v_lshrrev_b32 v7, 2, v2
v_mul_u32_u24 v7, 288, v7
v_and_b32 v8, 3, v2
v_lshl_add_u32 v7, v8, 3, v7
s_lshr_b32 s30, s3, 2
s_lshl_b32 s31, s30, 7
v_add_u32 v7, s31, v7
v_lshrrev_b32 v8, 4, v2
v_lshlrev_b32 v8, 17, v8
v_lshl_add_u32 v8, v14, 3, v8
s_lshl_b32 s32, s28, 19
s_add_u32 s32, s32, s22
s_lshl_b32 s33, s21, 8
s_add_u32 s32, s32, s33
s_add_u32 s32, s32, s31
s_add_u32 s32, s32, 0x100000
s_add_u32 s33, s32, 0x8000
s_add_u32 s34, s32, 0x10000
s_add_u32 s35, s32, 0x18000
v_mov_b32 v9, 0x3f803f80
v_mov_b32 v10, 0
v_mov_b32 v11, 0
v_mov_b32 v12, 0
v_mov_b32 v13, 0
s_cmp_lt_u32 s3, 8
s_cbranch_scc0 KA_NF
s_lshl_b32 s29, s28, 4
v_add_u32 v56, s29, v14
v_lshrrev_b32 v57, 1, v56
v_and_b32 v58, 1, v56
v_cmp_eq_u32 vcc, 1, v56
v_cvt_f32_u32 v57, v57
v_cvt_f32_u32 v58, v58
v_mov_b32 v59, 0x42000000
v_cndmask_b32 v57, v57, v59, vcc
v_cndmask_b32 v58, v58, 0, vcc
v_mul_f32 v57, 0x3c800000, v57
v_mul_f32 v58, 0x3e800000, v58
v_lshrrev_b32 v59, 4, v2
v_cvt_f32_u32 v59, v59
v_mul_f32 v59, 4.0, v59
v_fma_f32 v58, v59, v57, v58
v_fmamk_f32 v64, v57, 0x0, v58
v_cos_f32 v64, v64
v_fmamk_f32 v65, v57, 0x3f800000, v58
v_cos_f32 v65, v65
v_fmamk_f32 v66, v57, 0x40000000, v58
v_cos_f32 v66, v66
v_fmamk_f32 v67, v57, 0x40400000, v58
v_cos_f32 v67, v67
v_fmamk_f32 v68, v57, 0x41800000, v58
v_cos_f32 v68, v68
v_fmamk_f32 v69, v57, 0x41880000, v58
v_cos_f32 v69, v69
v_fmamk_f32 v70, v57, 0x41900000, v58
v_cos_f32 v70, v70
v_fmamk_f32 v71, v57, 0x41980000, v58
v_cos_f32 v71, v71
v_cvt_pk_bf16_f32 v48, v64, v65
v_cvt_pk_bf16_f32 v49, v66, v67
v_cvt_pk_bf16_f32 v50, v68, v69
v_cvt_pk_bf16_f32 v51, v70, v71
v_fmamk_f32 v64, v57, 0x42000000, v58
v_cos_f32 v64, v64
v_fmamk_f32 v65, v57, 0x42040000, v58
v_cos_f32 v65, v65
v_fmamk_f32 v66, v57, 0x42080000, v58
v_cos_f32 v66, v66
v_fmamk_f32 v67, v57, 0x420c0000, v58
v_cos_f32 v67, v67
v_fmamk_f32 v68, v57, 0x42400000, v58
v_cos_f32 v68, v68
v_fmamk_f32 v69, v57, 0x42440000, v58
v_cos_f32 v69, v69
v_fmamk_f32 v70, v57, 0x42480000, v58
v_cos_f32 v70, v70
v_fmamk_f32 v71, v57, 0x424c0000, v58
v_cos_f32 v71, v71
v_cvt_pk_bf16_f32 v52, v64, v65
v_cvt_pk_bf16_f32 v53, v66, v67
v_cvt_pk_bf16_f32 v54, v68, v69
v_cvt_pk_bf16_f32 v55, v70, v71
KA_NF:
s_waitcnt vmcnt(3)
v_dot2c_f32_bf16 v10, v16, v9
v_dot2c_f32_bf16 v12, v16, v16
v_dot2c_f32_bf16 v11, v17, v9
v_dot2c_f32_bf16 v13, v17, v17
v_dot2c_f32_bf16 v10, v18, v9
v_dot2c_f32_bf16 v12, v18, v18
v_dot2c_f32_bf16 v11, v19, v9
v_dot2c_f32_bf16 v13, v19, v19
v_lshlrev_b32 v32, 16, v16
v_and_b32 v33, 0xffff0000, v16
v_lshlrev_b32 v34, 16, v17
v_and_b32 v35, 0xffff0000, v17
v_lshlrev_b32 v36, 16, v18
v_and_b32 v37, 0xffff0000, v18
v_lshlrev_b32 v38, 16, v19
v_and_b32 v39, 0xffff0000, v19
s_waitcnt vmcnt(2)
v_dot2c_f32_bf16 v10, v20, v9
v_dot2c_f32_bf16 v12, v20, v20
v_dot2c_f32_bf16 v11, v21, v9
v_dot2c_f32_bf16 v13, v21, v21
v_dot2c_f32_bf16 v10, v22, v9
v_dot2c_f32_bf16 v12, v22, v22
v_dot2c_f32_bf16 v11, v23, v9
v_dot2c_f32_bf16 v13, v23, v23
s_waitcnt vmcnt(1)
v_dot2c_f32_bf16 v10, v24, v9
v_dot2c_f32_bf16 v12, v24, v24
v_dot2c_f32_bf16 v11, v25, v9
v_dot2c_f32_bf16 v13, v25, v25
v_dot2c_f32_bf16 v10, v26, v9
v_dot2c_f32_bf16 v12, v26, v26
v_dot2c_f32_bf16 v11, v27, v9
v_dot2c_f32_bf16 v13, v27, v27
s_waitcnt vmcnt(0)
v_dot2c_f32_bf16 v10, v28, v9
v_dot2c_f32_bf16 v12, v28, v28
v_dot2c_f32_bf16 v11, v29, v9
v_dot2c_f32_bf16 v13, v29, v29
v_dot2c_f32_bf16 v10, v30, v9
v_dot2c_f32_bf16 v12, v30, v30
v_dot2c_f32_bf16 v11, v31, v9
v_dot2c_f32_bf16 v13, v31, v31
s_nop 1
v_add_f32 v10, v10, v11
v_add_f32 v12, v12, v13
s_nop 0
v_add_f32_dpp v10, v10, v10 quad_perm:[1,0,3,2] row_mask:0xf bank_mask:0xf
v_add_f32_dpp v12, v12, v12 quad_perm:[1,0,3,2] row_mask:0xf bank_mask:0xf
s_nop 0
v_add_f32_dpp v10, v10, v10 quad_perm:[2,3,0,1] row_mask:0xf bank_mask:0xf
v_add_f32_dpp v12, v12, v12 quad_perm:[2,3,0,1] row_mask:0xf bank_mask:0xf
s_nop 0
v_add_f32_dpp v10, v10, v10 row_half_mirror row_mask:0xf bank_mask:0xf
v_add_f32_dpp v12, v12, v12 row_half_mirror row_mask:0xf bank_mask:0xf
s_nop 0
v_add_f32_dpp v10, v10, v10 row_mirror row_mask:0xf bank_mask:0xf
v_add_f32_dpp v12, v12, v12 row_mirror row_mask:0xf bank_mask:0xf
v_mul_f32 v10, 0x3b000000, v10
v_mul_f32 v12, 0x3b000000, v12
v_fma_f32 v12, -v10, v10, v12
v_max_f32 v12, 0, v12
v_cvt_pk_bf16_f32 v11, v10, v12
v_lshlrev_b32 v10, 16, v11
v_and_b32 v12, 0xffff0000, v11
v_add_f32 v12, 0x3727c5ac, v12
v_cvt_pk_bf16_f32 v12, v12, v12
v_sub_f32 v32, v32, v10
v_sub_f32 v33, v33, v10
v_sub_f32 v34, v34, v10
v_sub_f32 v35, v35, v10
v_sub_f32 v36, v36, v10
v_sub_f32 v37, v37, v10
v_sub_f32 v38, v38, v10
v_sub_f32 v39, v39, v10
v_lshlrev_b32 v12, 16, v12
v_sqrt_f32 v12, v12
v_cvt_pk_bf16_f32 v33, v32, v33
v_cvt_pk_bf16_f32 v35, v34, v35
v_cvt_pk_bf16_f32 v37, v36, v37
v_cvt_pk_bf16_f32 v39, v38, v39
v_cvt_pk_bf16_f32 v12, v12, v12
v_lshlrev_b32 v12, 16, v12
v_rcp_f32 v12, v12
v_lshlrev_b32 v32, 16, v33
v_and_b32 v33, 0xffff0000, v33
v_lshlrev_b32 v34, 16, v35
v_and_b32 v35, 0xffff0000, v35
v_lshlrev_b32 v36, 16, v37
v_and_b32 v37, 0xffff0000, v37
v_lshlrev_b32 v38, 16, v39
v_and_b32 v39, 0xffff0000, v39
v_mul_f32 v32, v32, v12
v_mul_f32 v33, v33, v12
v_mul_f32 v34, v34, v12
v_mul_f32 v35, v35, v12
v_mul_f32 v36, v36, v12
v_mul_f32 v37, v37, v12
v_mul_f32 v38, v38, v12
v_mul_f32 v39, v39, v12
v_cvt_pk_bf16_f32 v16, v32, v33
v_cvt_pk_bf16_f32 v17, v34, v35
v_cvt_pk_bf16_f32 v18, v36, v37
v_cvt_pk_bf16_f32 v19, v38, v39
ds_write_b128 v6, v[16:19]
s_waitcnt lgkmcnt(0)
s_barrier
s_mov_b32 s42, 1
s_cmp_eq_u32 s3, 8
s_cbranch_scc1 KA_SIG
s_cmp_lt_u32 s3, 8
s_cbranch_scc0 KA_NEXT
ds_read_b64_tr_b16 v[64:65], v7 offset:0
ds_read_b64_tr_b16 v[66:67], v7 offset:4608
ds_read_b64_tr_b16 v[72:73], v7 offset:32
ds_read_b64_tr_b16 v[74:75], v7 offset:4640
ds_read_b64_tr_b16 v[80:81], v7 offset:64
ds_read_b64_tr_b16 v[82:83], v7 offset:4672
ds_read_b64_tr_b16 v[88:89], v7 offset:96
ds_read_b64_tr_b16 v[90:91], v7 offset:4704
ds_read_b64_tr_b16 v[68:69], v7 offset:9216
ds_read_b64_tr_b16 v[70:71], v7 offset:13824
ds_read_b64_tr_b16 v[76:77], v7 offset:9248
ds_read_b64_tr_b16 v[78:79], v7 offset:13856
ds_read_b64_tr_b16 v[84:85], v7 offset:9280
ds_read_b64_tr_b16 v[86:87], v7 offset:13888
ds_read_b64_tr_b16 v[92:93], v7 offset:9312
ds_read_b64_tr_b16 v[94:95], v7 offset:13920
s_waitcnt vmcnt(0)
s_waitcnt lgkmcnt(14)
v_mfma_f32_16x16x32_bf16 v[24:27], v[48:51], v[64:67], 0
s_waitcnt lgkmcnt(12)
v_mfma_f32_16x16x32_bf16 v[28:31], v[48:51], v[72:75], 0
s_waitcnt lgkmcnt(10)
v_mfma_f32_16x16x32_bf16 v[32:35], v[48:51], v[80:83], 0
s_waitcnt lgkmcnt(8)
v_mfma_f32_16x16x32_bf16 v[36:39], v[48:51], v[88:91], 0
s_waitcnt lgkmcnt(6)
v_mfma_f32_16x16x32_bf16 v[24:27], v[52:55], v[68:71], v[24:27]
s_waitcnt lgkmcnt(4)
v_mfma_f32_16x16x32_bf16 v[28:31], v[52:55], v[76:79], v[28:31]
s_waitcnt lgkmcnt(2)
v_mfma_f32_16x16x32_bf16 v[32:35], v[52:55], v[84:87], v[32:35]
s_waitcnt lgkmcnt(0)
v_mfma_f32_16x16x32_bf16 v[36:39], v[52:55], v[92:95], v[36:39]
s_nop 3
v_cvt_pk_bf16_f32 v16, v24, v28
s_nop 2
v_cvt_pk_bf16_f32 v17, v32, v36
buffer_store_dwordx2 v[16:17], v8, s[12:15], s32 offen sc1
v_cvt_pk_bf16_f32 v18, v25, v29
v_cvt_pk_bf16_f32 v19, v33, v37
buffer_store_dwordx2 v[18:19], v8, s[12:15], s33 offen sc1
v_cvt_pk_bf16_f32 v20, v26, v30
v_cvt_pk_bf16_f32 v21, v34, v38
buffer_store_dwordx2 v[20:21], v8, s[12:15], s34 offen sc1
v_cvt_pk_bf16_f32 v22, v27, v31
v_cvt_pk_bf16_f32 v23, v35, v39
buffer_store_dwordx2 v[22:23], v8, s[12:15], s35 offen sc1
s_waitcnt vmcnt(0)
s_barrier
s_mov_b32 s42, 0
s_branch KA_NEXT
KA_SIG:
s_mov_b64 exec, 1
v_mov_b32 v60, 0
s_mov_b32 s61, 0x40000
TAG_A:
buffer_load_dword v61, v60, s[36:39], 0 offen sc1
s_sub_u32 s61, s61, 1
s_cmp_eq_u32 s61, 0
s_cbranch_scc1 TAGD_A
s_waitcnt vmcnt(0)
v_readfirstlane_b32 s62, v61
s_cmp_eq_u32 s62, 0
s_cbranch_scc1 TAG_A
TAGD_A:
s_barrier
s_mov_b64 exec, 255
v_lshlrev_b32 v60, 13, v2
v_mov_b32 v61, s62
s_lshl_b32 s61, s2, 4
s_add_u32 s61, s61, 0x40000
buffer_store_dword v61, v60, s[12:15], s61 offen sc1
s_mov_b64 exec, -1
s_mov_b32 s42, 0
KA_NEXT:
s_endpgm
K12_OTHER:
s_cmp_ge_u32 s2, 398
s_cbranch_scc1 K12_END
s_load_dwordx4 s[56:59], s[0:1], 32
s_load_dwordx2 s[54:55], s[0:1], 48
v_lshrrev_b32 v1, 6, v0
v_and_b32 v2, 63, v0
v_lshlrev_b32 v3, 4, v2
v_readfirstlane_b32 s3, v1
s_mov_b32 s38, 256
s_mov_b32 s42, 0
s_mov_b32 s39, 0x00020000
s_mov_b32 s14, 0x2000000
s_mov_b32 s15, 0x00020000
s_waitcnt lgkmcnt(0)
s_mov_b32 s36, s4
s_mov_b32 s37, s5
s_mov_b32 s12, s6
s_mov_b32 s13, s7
K12_SIDE:
v_lshrrev_b32 v13, 4, v2
v_and_b32 v4, 15, v2
s_lshl_b32 s31, s3, 11
s_add_u32 s31, s31, 0x8000
v_add_u32 v14, s31, v3
s_sub_u32 s20, s2, 354
s_cmp_ge_u32 s2, 354
s_cbranch_scc1 K2_WD
s_sub_u32 s20, s2, 258
s_and_b32 s22, s20, 1
s_bfe_u32 s23, s20, 0x20001
s_lshr_b32 s24, s20, 4
s_lshl_b32 s24, s24, 2
s_add_u32 s23, s23, s24
s_lshl_b32 s23, s23, 1
s_bfe_u32 s24, s20, 0x10003
s_add_u32 s23, s23, s24
s_cmp_gt_u32 s23, 43
s_cbranch_scc1 K12_END
s_cmp_eq_u32 s22, 0
s_cselect_b32 s4, s56, s58
s_cselect_b32 s5, s57, s59
s_mul_i32 s25, s3, 88064
s_lshl_b32 s26, s23, 6
s_add_u32 s25, s25, s26
v_mul_u32_u24 v7, 22016, v13
v_lshl_add_u32 v7, v4, 2, v7
v_lshrrev_b32 v6, 3, v4
v_and_b32 v5, 7, v4
v_lshlrev_b32 v8, 10, v6
v_lshl_add_u32 v8, v13, 8, v8
v_lshl_add_u32 v8, v5, 5, v8
v_add_u32 v8, s31, v8
v_lshrrev_b32 v5, 1, v13
v_lshlrev_b32 v5, 14, v5
v_and_b32 v6, 1, v13
v_lshl_add_u32 v5, v6, 9, v5
v_lshl_add_u32 v5, v4, 4, v5
s_lshl_b32 s26, s23, 16
s_lshl_b32 s27, s22, 8
s_add_u32 s26, s26, s27
s_lshl_b32 s27, s3, 10
s_add_u32 s26, s26, s27
s_add_u32 s26, s26, 0x800000
v_lshlrev_b32 v9, 5, v13
s_lshl_b32 s28, s3, 7
s_add_u32 s28, s28, 6144
s_waitcnt lgkmcnt(0)
s_mov_b32 s8, s4
s_mov_b32 s9, s5
s_mov_b32 s10, 0x158000
s_mov_b32 s11, 0x00020000
s_cmp_eq_u32 s23, 43
s_cmov_b32 s10, 0
s_mov_b32 s12, s6
s_mov_b32 s13, s7
s_mov_b32 s14, 0x2000000
s_mov_b32 s15, 0x00020000
buffer_load_dword v16, v7, s[8:11], s25 offen
s_add_u32 s25, s25, 2752
buffer_load_dword v17, v7, s[8:11], s25 offen
s_add_u32 s25, s25, 2752
buffer_load_dword v18, v7, s[8:11], s25 offen
s_add_u32 s25, s25, 2752
buffer_load_dword v19, v7, s[8:11], s25 offen
s_add_u32 s25, s25, 2752
buffer_load_dword v20, v7, s[8:11], s25 offen
s_add_u32 s25, s25, 2752
buffer_load_dword v21, v7, s[8:11], s25 offen
s_add_u32 s25, s25, 2752
buffer_load_dword v22, v7, s[8:11], s25 offen
s_add_u32 s25, s25, 2752
buffer_load_dword v23, v7, s[8:11], s25 offen
s_add_u32 s25, s25, 2752
s_cmp_eq_u32 s42, 0
s_cbranch_scc1 KU_NB
s_barrier
KU_NB:
s_cmp_eq_u32 s3, 9
s_cbranch_scc0 KU_W
s_mov_b64 exec, 1
v_mov_b32 v60, 0
s_mov_b32 s61, 0x40000
TAG_U:
buffer_load_dword v61, v60, s[36:39], 0 offen sc1
s_sub_u32 s61, s61, 1
s_cmp_eq_u32 s61, 0
s_cbranch_scc1 TAGD_U
s_waitcnt vmcnt(0)
v_readfirstlane_b32 s62, v61
s_cmp_eq_u32 s62, 0
s_cbranch_scc1 TAG_U
TAGD_U:
s_lshl_b32 s63, s20, 11
s_add_u32 s63, s63, 0x80000
s_mov_b64 exec, -1
v_and_b32 v60, 15, v2
v_lshlrev_b32 v60, 2, v60
s_mov_b32 s61, 0x40000
ML_U:
buffer_load_dword v61, v60, s[12:15], s63 offen offset:0 sc1
s_sub_u32 s61, s61, 1
s_cmp_eq_u32 s61, 0
s_cbranch_scc1 MD_U
s_waitcnt vmcnt(0)
v_cmp_ne_u32 vcc, s62, v61
s_cbranch_vccnz ML_U
MD_U:
KU_W:
s_barrier
buffer_load_dwordx4 v[32:35], v9, s[12:15], s28 offen offset:0 sc1
buffer_load_dwordx4 v[36:39], v9, s[12:15], s28 offen offset:16 sc1
buffer_load_dwordx4 v[40:43], v9, s[12:15], s28 offen offset:2048 sc1
buffer_load_dwordx4 v[44:47], v9, s[12:15], s28 offen offset:2064 sc1
v_mov_b32 v72, 0
v_mov_b32 v73, 0
v_mov_b32 v74, 0
v_mov_b32 v75, 0
v_mov_b32 v10, 0x3f803f80
s_waitcnt vmcnt(0)
v_lshlrev_b32 v64, 16, v16
v_fmac_f32 v74, v64, v32
v_mul_f32 v64, v64, v40
v_lshlrev_b32 v65, 16, v17
v_fmac_f32 v74, v65, v33
v_mul_f32 v65, v65, v41
v_cvt_pk_bf16_f32 v48, v64, v65
v_dot2c_f32_bf16 v72, v48, v10
v_and_b32 v66, 0xffff0000, v16
v_fmac_f32 v75, v66, v32
v_mul_f32 v66, v66, v40
v_and_b32 v67, 0xffff0000, v17
v_fmac_f32 v75, v67, v33
v_mul_f32 v67, v67, v41
v_cvt_pk_bf16_f32 v52, v66, v67
v_dot2c_f32_bf16 v73, v52, v10
v_lshlrev_b32 v68, 16, v18
v_fmac_f32 v74, v68, v34
v_mul_f32 v68, v68, v42
v_lshlrev_b32 v69, 16, v19
v_fmac_f32 v74, v69, v35
v_mul_f32 v69, v69, v43
v_cvt_pk_bf16_f32 v49, v68, v69
v_dot2c_f32_bf16 v72, v49, v10
v_and_b32 v70, 0xffff0000, v18
v_fmac_f32 v75, v70, v34
v_mul_f32 v70, v70, v42
v_and_b32 v71, 0xffff0000, v19
v_fmac_f32 v75, v71, v35
v_mul_f32 v71, v71, v43
v_cvt_pk_bf16_f32 v53, v70, v71
v_dot2c_f32_bf16 v73, v53, v10
v_lshlrev_b32 v64, 16, v20
v_fmac_f32 v74, v64, v36
v_mul_f32 v64, v64, v44
v_lshlrev_b32 v65, 16, v21
v_fmac_f32 v74, v65, v37
v_mul_f32 v65, v65, v45
v_cvt_pk_bf16_f32 v50, v64, v65
v_dot2c_f32_bf16 v72, v50, v10
v_and_b32 v66, 0xffff0000, v20
v_fmac_f32 v75, v66, v36
v_mul_f32 v66, v66, v44
v_and_b32 v67, 0xffff0000, v21
v_fmac_f32 v75, v67, v37
v_mul_f32 v67, v67, v45
v_cvt_pk_bf16_f32 v54, v66, v67
v_dot2c_f32_bf16 v73, v54, v10
v_lshlrev_b32 v68, 16, v22
v_fmac_f32 v74, v68, v38
v_mul_f32 v68, v68, v46
v_lshlrev_b32 v69, 16, v23
v_fmac_f32 v74, v69, v39
v_mul_f32 v69, v69, v47
v_cvt_pk_bf16_f32 v51, v68, v69
v_dot2c_f32_bf16 v72, v51, v10
v_and_b32 v70, 0xffff0000, v22
v_fmac_f32 v75, v70, v38
v_mul_f32 v70, v70, v46
v_and_b32 v71, 0xffff0000, v23
v_fmac_f32 v75, v71, v39
v_mul_f32 v71, v71, v47
v_cvt_pk_bf16_f32 v55, v70, v71
v_dot2c_f32_bf16 v73, v55, v10
ds_write_b128 v8, v[48:51] offset:0
ds_write_b128 v8, v[52:55] offset:16
v_lshl_add_u32 v11, v1, 2, v13
v_lshlrev_b32 v11, 8, v11
v_lshl_add_u32 v11, v4, 3, v11
ds_write2_b64 v11, v[72:73], v[74:75] offset0:0 offset1:16
ds_read_b128 v[16:19], v14 offset:0
ds_read_b128 v[20:23], v14 offset:1024
s_lshl_b32 s24, s3, 10
v_lshl_add_u32 v15, v2, 2, s24
s_waitcnt lgkmcnt(1)
buffer_store_dwordx4 v[16:19], v5, s[12:15], s26 offen sc1
s_add_u32 s26, s26, 0x8000
s_waitcnt lgkmcnt(0)
buffer_store_dwordx4 v[20:23], v5, s[12:15], s26 offen sc1
s_add_u32 s26, s26, 0x8000
ds_read2st64_b32 v[32:33], v15 offset0:0 offset1:1
ds_read2st64_b32 v[34:35], v15 offset0:2 offset1:3
v_lshlrev_b32 v12, 2, v0
s_waitcnt lgkmcnt(0)
v_add_f32 v32, v32, v33
v_add_f32 v34, v34, v35
v_add_f32 v32, v32, v34
ds_write_b32 v12, v32 offset:16384
s_waitcnt lgkmcnt(0)
s_barrier
s_cmp_ge_u32 s3, 1
s_cbranch_scc1 K12_END
ds_read2st64_b32 v[32:33], v12 offset0:64 offset1:65
ds_read2st64_b32 v[34:35], v12 offset0:66 offset1:67
ds_read2st64_b32 v[36:37], v12 offset0:68 offset1:69
ds_read2st64_b32 v[38:39], v12 offset0:70 offset1:71
ds_read2st64_b32 v[40:41], v12 offset0:72 offset1:73
ds_read2st64_b32 v[42:43], v12 offset0:74 offset1:75
ds_read2st64_b32 v[44:45], v12 offset0:76 offset1:77
ds_read2st64_b32 v[46:47], v12 offset0:78 offset1:79
v_and_b32 v15, 1, v13
v_lshlrev_b32 v15, 8, v15
v_lshrrev_b32 v11, 1, v13
v_lshl_add_u32 v15, v11, 6, v15
v_lshl_add_u32 v15, v4, 2, v15
s_lshl_b32 s24, s23, 9
s_lshl_b32 s25, s22, 7
s_add_u32 s24, s24, s25
s_add_u32 s24, s24, 0x8000
s_waitcnt lgkmcnt(0)
v_add_f32 v32, v32, v40
v_add_f32 v33, v33, v41
v_add_f32 v34, v34, v42
v_add_f32 v35, v35, v43
v_add_f32 v36, v36, v44
v_add_f32 v37, v37, v45
v_add_f32 v38, v38, v46
v_add_f32 v39, v39, v47
v_add_f32 v32, v32, v36
v_add_f32 v33, v33, v37
v_add_f32 v34, v34, v38
v_add_f32 v35, v35, v39
v_add_f32 v32, v32, v34
v_add_f32 v33, v33, v35
v_add_f32 v32, v32, v33
buffer_store_dword v32, v15, s[12:15], s24 offen
s_endpgm
K2_WD:
s_mov_b32 s4, s54
s_mov_b32 s5, s55
s_mov_b32 s21, s20
s_lshr_b32 s22, s3, 1
s_and_b32 s23, s3, 1
s_lshl_b32 s25, s21, 15
s_lshl_b32 s26, s3, 6
s_add_u32 s25, s25, s26
s_add_u32 s24, s25, 8192
v_lshrrev_b32 v7, 1, v13
v_lshlrev_b32 v7, 14, v7
v_and_b32 v9, 1, v13
v_lshl_add_u32 v7, v9, 12, v7
v_lshl_add_u32 v7, v4, 2, v7
v_lshlrev_b32 v8, 9, v13
v_lshrrev_b32 v5, 3, v4
v_lshl_add_u32 v8, v5, 8, v8
v_bfe_u32 v5, v4, 1, 1
v_lshl_add_u32 v8, v5, 7, v8
v_bfe_u32 v5, v4, 2, 1
v_lshl_add_u32 v8, v5, 6, v8
v_and_b32 v5, 1, v4
v_lshl_add_u32 v8, v5, 5, v8
v_add_u32 v8, s31, v8
v_mov_b32 v10, v3
s_mul_i32 s26, s22, 180224
s_lshl_b32 s27, s21, 12
s_add_u32 s26, s26, s27
s_lshl_b32 s27, s23, 10
s_add_u32 s26, s26, s27
s_add_u32 s26, s26, 0xb00000
s_waitcnt lgkmcnt(0)
s_mov_b32 s8, s4
s_mov_b32 s9, s5
s_mov_b32 s10, 0x158000
s_mov_b32 s11, 0x00020000
s_mov_b32 s12, s6
s_mov_b32 s13, s7
s_mov_b32 s14, 0x2000000
s_mov_b32 s15, 0x00020000
buffer_load_dword v16, v7, s[8:11], s25 offen offset:0
buffer_load_dword v17, v7, s[8:11], s25 offen offset:1024
buffer_load_dword v18, v7, s[8:11], s25 offen offset:2048
buffer_load_dword v19, v7, s[8:11], s25 offen offset:3072
buffer_load_dword v20, v7, s[8:11], s24 offen offset:0
buffer_load_dword v21, v7, s[8:11], s24 offen offset:1024
buffer_load_dword v22, v7, s[8:11], s24 offen offset:2048
buffer_load_dword v23, v7, s[8:11], s24 offen offset:3072
s_cmp_eq_u32 s42, 0
s_cbranch_scc1 KD_NB
s_barrier
KD_NB:
s_mov_b32 s41, 0x05040100
s_mov_b32 s42, 0x07060302
s_waitcnt vmcnt(0)
v_perm_b32 v32, v17, v16, s41
v_perm_b32 v33, v19, v18, s41
v_perm_b32 v34, v21, v20, s41
v_perm_b32 v35, v23, v22, s41
ds_write_b128 v8, v[32:35] offset:0
v_perm_b32 v36, v17, v16, s42
v_perm_b32 v37, v19, v18, s42
v_perm_b32 v38, v21, v20, s42
v_perm_b32 v39, v23, v22, s42
ds_write_b128 v8, v[36:39] offset:16
ds_read_b128 v[48:51], v14 offset:0
ds_read_b128 v[52:55], v14 offset:1024
s_waitcnt lgkmcnt(1)
buffer_store_dwordx4 v[48:51], v10, s[12:15], s26 offen offset:0 sc1
s_waitcnt lgkmcnt(0)
buffer_store_dwordx4 v[52:55], v10, s[12:15], s26 offen offset:2048 sc1
s_endpgm
KG_BN:
v_lshrrev_b32 v1, 6, v0
v_and_b32 v2, 63, v0
v_lshlrev_b32 v3, 4, v2
v_readfirstlane_b32 s3, v1
s_mov_b32 s38, 256
s_mov_b32 s42, 0
s_mov_b32 s39, 0x00020000
s_mov_b32 s14, 0x2000000
s_mov_b32 s15, 0x00020000
s_mov_b32 s36, s4
s_mov_b32 s37, s5
s_mov_b32 s12, s6
s_mov_b32 s13, s7
v_lshlrev_b32 v4, 2, v0
v_mov_b32 v40, 0
v_mov_b32 v41, 0
v_mov_b32 v42, 0
v_mov_b32 v43, 0
v_mov_b32 v44, 0
v_mov_b32 v45, 0
v_mov_b32 v46, 0
v_mov_b32 v47, 0
s_waitcnt vmcnt(0)
v_lshlrev_b32 v32, 16, v32
v_mul_f32 v8, 0xbfb8aa3b, v32
v_exp_f32 v8, v8
s_nop 0
v_add_f32 v8, 1.0, v8
v_rcp_f32 v8, v8
s_nop 0
v_mul_f32 v32, v32, v8
v_cvt_pk_bf16_f32 v32, v32, v32
v_and_b32 v36, 0xffff0000, v32
v_and_b32 v32, 0xffff, v32
v_lshlrev_b32 v33, 16, v33
v_mul_f32 v9, 0xbfb8aa3b, v33
v_exp_f32 v9, v9
s_nop 0
v_add_f32 v9, 1.0, v9
v_rcp_f32 v9, v9
s_nop 0
v_mul_f32 v33, v33, v9
v_cvt_pk_bf16_f32 v33, v33, v33
v_and_b32 v37, 0xffff0000, v33
v_and_b32 v33, 0xffff, v33
v_dot2c_f32_bf16 v40, v16, v32
v_dot2c_f32_bf16 v41, v16, v36
v_dot2c_f32_bf16 v42, v17, v32
v_dot2c_f32_bf16 v43, v17, v36
v_dot2c_f32_bf16 v44, v18, v32
v_dot2c_f32_bf16 v45, v18, v36
v_dot2c_f32_bf16 v46, v19, v32
v_dot2c_f32_bf16 v47, v19, v36
v_dot2c_f32_bf16 v40, v20, v33
v_dot2c_f32_bf16 v41, v20, v37
v_dot2c_f32_bf16 v42, v21, v33
v_dot2c_f32_bf16 v43, v21, v37
v_dot2c_f32_bf16 v44, v22, v33
v_dot2c_f32_bf16 v45, v22, v37
v_dot2c_f32_bf16 v46, v23, v33
v_dot2c_f32_bf16 v47, v23, v37
v_lshlrev_b32 v5, 5, v0
ds_write_b128 v5, v[40:43] offset:4096
s_nop 0
ds_write_b128 v5, v[44:47] offset:4112
s_lshl_b32 s22, s3, 11
s_add_u32 s22, s22, 4096
v_lshl_add_u32 v8, v2, 2, s22
ds_read2st64_b32 v[16:17], v8 offset0:0 offset1:1
ds_read2st64_b32 v[18:19], v8 offset0:2 offset1:3
ds_read2st64_b32 v[20:21], v8 offset0:4 offset1:5
ds_read2st64_b32 v[22:23], v8 offset0:6 offset1:7
s_waitcnt lgkmcnt(0)
v_add_f32 v16, v16, v17
v_add_f32 v18, v18, v19
v_add_f32 v20, v20, v21
v_add_f32 v22, v22, v23
v_add_f32 v16, v16, v18
v_add_f32 v20, v20, v22
v_add_f32 v16, v16, v20
ds_write_b32 v4, v16
s_cmp_eq_u32 s3, 0
s_cbranch_scc1 KG_TN
s_waitcnt lgkmcnt(0)
s_barrier
s_branch KG_NEXT
KG_TN:
s_mov_b64 exec, 1
v_mov_b32 v60, 0
s_mov_b32 s61, 0x40000
TAG_GN:
buffer_load_dword v61, v60, s[36:39], 0 offen sc1
s_sub_u32 s61, s61, 1
s_cmp_eq_u32 s61, 0
s_cbranch_scc1 TAGD_GN
s_waitcnt vmcnt(0)
v_readfirstlane_b32 s62, v61
s_cmp_eq_u32 s62, 0
s_cbranch_scc1 TAG_GN
TAGD_GN:
s_mov_b64 exec, -1
s_waitcnt lgkmcnt(0)
s_barrier
ds_read2st64_b32 v[16:17], v4 offset0:0 offset1:1
ds_read2st64_b32 v[18:19], v4 offset0:2 offset1:3
ds_read2st64_b32 v[20:21], v4 offset0:4 offset1:5
ds_read2st64_b32 v[22:23], v4 offset0:6 offset1:7
ds_read2st64_b32 v[24:25], v4 offset0:8 offset1:9
ds_read2st64_b32 v[26:27], v4 offset0:10 offset1:11
ds_read2st64_b32 v[28:29], v4 offset0:12 offset1:13
ds_read2st64_b32 v[30:31], v4 offset0:14 offset1:15
s_lshr_b32 s21, s20, 3
v_and_b32 v4, 63, v2
v_lshlrev_b32 v4, 2, v4
s_waitcnt lgkmcnt(0)
v_add_f32 v16, v16, v24
v_add_f32 v17, v17, v25
v_add_f32 v18, v18, v26
v_add_f32 v19, v19, v27
v_add_f32 v20, v20, v28
v_add_f32 v21, v21, v29
v_add_f32 v22, v22, v30
v_add_f32 v23, v23, v31
v_add_f32 v16, v16, v17
v_add_f32 v18, v18, v19
v_add_f32 v20, v20, v21
v_add_f32 v22, v22, v23
v_add_f32 v16, v16, v18
v_add_f32 v20, v20, v22
v_add_f32 v16, v16, v20
s_lshl_b32 s23, s20, 8
s_lshl_b32 s22, s41, 12
s_add_u32 s23, s23, s22
s_add_u32 s23, s23, 0x4000
s_lshl_b32 s23, s20, 9
s_lshl_b32 s22, s41, 13
s_add_u32 s23, s23, s22
s_add_u32 s23, s23, 0x30000
v_lshlrev_b32 v4, 1, v4
v_mov_b32 v17, s62
buffer_store_dwordx2 v[16:17], v4, s[12:15], s23 offen sc1
s_branch KG_EN
buffer_store_dword v16, v4, s[12:15], s23 offen sc1
s_cmp_ge_u32 s40, 176
s_cbranch_scc1 KG_EN
s_waitcnt vmcnt(0)
s_mov_b64 exec, -1
v_lshlrev_b32 v60, 11, v2
v_mov_b32 v61, s62
s_lshl_b32 s61, s40, 2
s_add_u32 s61, s61, 0x40000
buffer_store_dword v61, v60, s[12:15], s61 offen sc1
s_add_u32 s61, s61, 0x20000
s_mov_b32 exec_lo, 0x3
s_mov_b32 exec_hi, 0x0
buffer_store_dword v61, v60, s[12:15], s61 offen sc1
s_mov_b64 exec, -1
KG_EN:
KG_NEXT:
s_endpgm
KG_BW:
s_add_u32 s21, s21, 1572864
s_add_u32 s22, s22, 1572864
buffer_load_dwordx4 v[24:27], v13, s[44:47], s21 offen
buffer_load_dwordx4 v[28:31], v13, s[44:47], s22 offen
buffer_load_ushort v34, v6, s[8:11], 0 offen offset:512
buffer_load_ushort v35, v6, s[8:11], 0 offen offset:768
v_lshrrev_b32 v1, 6, v0
v_and_b32 v2, 63, v0
v_lshlrev_b32 v3, 4, v2
v_readfirstlane_b32 s3, v1
s_mov_b32 s38, 256
s_mov_b32 s42, 0
s_mov_b32 s39, 0x00020000
s_mov_b32 s14, 0x2000000
s_mov_b32 s15, 0x00020000
s_mov_b32 s36, s4
s_mov_b32 s37, s5
s_mov_b32 s12, s6
s_mov_b32 s13, s7
v_lshlrev_b32 v4, 2, v0
v_mov_b32 v40, 0
v_mov_b32 v41, 0
v_mov_b32 v42, 0
v_mov_b32 v43, 0
v_mov_b32 v44, 0
v_mov_b32 v45, 0
v_mov_b32 v46, 0
v_mov_b32 v47, 0
s_cmp_eq_u32 s20, 16
s_cbranch_scc0 KG_NOZ
v_lshlrev_b32 v7, 4, v0
s_mov_b32 s22, 0x10000
buffer_store_dwordx4 v[40:43], v7, s[12:15], s22 offen
s_waitcnt vmcnt(0)
KG_NOZ:
s_waitcnt vmcnt(0)
v_lshlrev_b32 v32, 16, v32
v_mul_f32 v8, 0xbfb8aa3b, v32
v_exp_f32 v8, v8
s_nop 0
v_add_f32 v8, 1.0, v8
v_rcp_f32 v8, v8
s_nop 0
v_mul_f32 v32, v32, v8
v_cvt_pk_bf16_f32 v32, v32, v32
v_and_b32 v36, 0xffff0000, v32
v_and_b32 v32, 0xffff, v32
v_lshlrev_b32 v33, 16, v33
v_mul_f32 v9, 0xbfb8aa3b, v33
v_exp_f32 v9, v9
s_nop 0
v_add_f32 v9, 1.0, v9
v_rcp_f32 v9, v9
s_nop 0
v_mul_f32 v33, v33, v9
v_cvt_pk_bf16_f32 v33, v33, v33
v_and_b32 v37, 0xffff0000, v33
v_and_b32 v33, 0xffff, v33
v_lshlrev_b32 v34, 16, v34
v_mul_f32 v10, 0xbfb8aa3b, v34
v_exp_f32 v10, v10
s_nop 0
v_add_f32 v10, 1.0, v10
v_rcp_f32 v10, v10
s_nop 0
v_mul_f32 v34, v34, v10
v_cvt_pk_bf16_f32 v34, v34, v34
v_and_b32 v38, 0xffff0000, v34
v_and_b32 v34, 0xffff, v34
v_lshlrev_b32 v35, 16, v35
v_mul_f32 v11, 0xbfb8aa3b, v35
v_exp_f32 v11, v11
s_nop 0
v_add_f32 v11, 1.0, v11
v_rcp_f32 v11, v11
s_nop 0
v_mul_f32 v35, v35, v11
v_cvt_pk_bf16_f32 v35, v35, v35
v_and_b32 v39, 0xffff0000, v35
v_and_b32 v35, 0xffff, v35
v_dot2c_f32_bf16 v40, v16, v32
v_dot2c_f32_bf16 v41, v16, v36
v_dot2c_f32_bf16 v42, v17, v32
v_dot2c_f32_bf16 v43, v17, v36
v_dot2c_f32_bf16 v44, v18, v32
v_dot2c_f32_bf16 v45, v18, v36
v_dot2c_f32_bf16 v46, v19, v32
v_dot2c_f32_bf16 v47, v19, v36
v_dot2c_f32_bf16 v40, v20, v33
v_dot2c_f32_bf16 v41, v20, v37
v_dot2c_f32_bf16 v42, v21, v33
v_dot2c_f32_bf16 v43, v21, v37
v_dot2c_f32_bf16 v44, v22, v33
v_dot2c_f32_bf16 v45, v22, v37
v_dot2c_f32_bf16 v46, v23, v33
v_dot2c_f32_bf16 v47, v23, v37
v_dot2c_f32_bf16 v40, v24, v34
v_dot2c_f32_bf16 v41, v24, v38
v_dot2c_f32_bf16 v42, v25, v34
v_dot2c_f32_bf16 v43, v25, v38
v_dot2c_f32_bf16 v44, v26, v34
v_dot2c_f32_bf16 v45, v26, v38
v_dot2c_f32_bf16 v46, v27, v34
v_dot2c_f32_bf16 v47, v27, v38
v_dot2c_f32_bf16 v40, v28, v35
v_dot2c_f32_bf16 v41, v28, v39
v_dot2c_f32_bf16 v42, v29, v35
v_dot2c_f32_bf16 v43, v29, v39
v_dot2c_f32_bf16 v44, v30, v35
v_dot2c_f32_bf16 v45, v30, v39
v_dot2c_f32_bf16 v46, v31, v35
v_dot2c_f32_bf16 v47, v31, v39
v_add_u32 v4, 0x12000, v4
v_lshlrev_b32 v5, 5, v0
ds_write_b128 v5, v[40:43] offset:4096
ds_write_b128 v5, v[44:47] offset:4112
s_lshl_b32 s22, s3, 11
s_add_u32 s22, s22, 4096
v_lshl_add_u32 v8, v2, 2, s22
ds_read2st64_b32 v[16:17], v8 offset0:0 offset1:1
ds_read2st64_b32 v[18:19], v8 offset0:2 offset1:3
ds_read2st64_b32 v[20:21], v8 offset0:4 offset1:5
ds_read2st64_b32 v[22:23], v8 offset0:6 offset1:7
s_waitcnt lgkmcnt(0)
v_add_f32 v16, v16, v17
v_add_f32 v18, v18, v19
v_add_f32 v20, v20, v21
v_add_f32 v22, v22, v23
v_add_f32 v16, v16, v18
v_add_f32 v20, v20, v22
v_add_f32 v16, v16, v20
ds_write_b32 v4, v16
s_cmp_eq_u32 s3, 0
s_cbranch_scc1 KG_TW
s_waitcnt lgkmcnt(0)
s_barrier
s_endpgm
KG_TW:
s_mov_b64 exec, 1
v_mov_b32 v60, 0
s_mov_b32 s61, 0x40000
TAG_GW:
buffer_load_dword v61, v60, s[36:39], 0 offen sc1
s_sub_u32 s61, s61, 1
s_cmp_eq_u32 s61, 0
s_cbranch_scc1 TAGD_GW
s_waitcnt vmcnt(0)
v_readfirstlane_b32 s62, v61
s_cmp_eq_u32 s62, 0
s_cbranch_scc1 TAG_GW
TAGD_GW:
s_mov_b64 exec, -1
s_waitcnt lgkmcnt(0)
s_barrier
ds_read2st64_b32 v[16:17], v4 offset0:0 offset1:1
ds_read2st64_b32 v[18:19], v4 offset0:2 offset1:3
ds_read2st64_b32 v[20:21], v4 offset0:4 offset1:5
ds_read2st64_b32 v[22:23], v4 offset0:6 offset1:7
ds_read2st64_b32 v[24:25], v4 offset0:8 offset1:9
ds_read2st64_b32 v[26:27], v4 offset0:10 offset1:11
ds_read2st64_b32 v[28:29], v4 offset0:12 offset1:13
ds_read2st64_b32 v[30:31], v4 offset0:14 offset1:15
s_lshr_b32 s21, s20, 3
v_and_b32 v4, 63, v2
v_lshlrev_b32 v4, 2, v4
s_waitcnt lgkmcnt(0)
v_add_f32 v16, v16, v24
v_add_f32 v17, v17, v25
v_add_f32 v18, v18, v26
v_add_f32 v19, v19, v27
v_add_f32 v20, v20, v28
v_add_f32 v21, v21, v29
v_add_f32 v22, v22, v30
v_add_f32 v23, v23, v31
v_add_f32 v16, v16, v17
v_add_f32 v18, v18, v19
v_add_f32 v20, v20, v21
v_add_f32 v22, v22, v23
v_add_f32 v16, v16, v18
v_add_f32 v20, v20, v22
v_add_f32 v16, v16, v20
v_cvt_pk_bf16_f32 v16, v16, v16
v_lshlrev_b32 v16, 16, v16
s_cmp_eq_u32 s21, 4
s_cselect_b32 s23, 1.0, 0
v_add_f32 v16, s23, v16
v_cvt_pk_bf16_f32 v16, v16, v16
v_lshlrev_b32 v16, 16, v16
s_lshl_b32 s23, s20, 8
buffer_store_dword v16, v4, s[12:15], s23 offen sc1
s_cmp_ge_u32 s40, 176
s_cbranch_scc1 KG_EW
s_waitcnt vmcnt(0)
s_mov_b64 exec, -1
v_lshlrev_b32 v60, 11, v2
v_mov_b32 v61, s62
s_lshl_b32 s61, s40, 2
s_add_u32 s61, s61, 0x7fd80
buffer_store_dword v61, v60, s[12:15], s61 offen sc1
s_add_u32 s61, s61, 0x20000
s_mov_b32 exec_lo, 0xffffffff
s_mov_b32 exec_hi, 0x0
buffer_store_dword v61, v60, s[12:15], s61 offen sc1
s_mov_b64 exec, -1
KG_EW:
s_endpgm
K12_END:
s_endpgm
.globl k34_kernel
.p2align 8
.type k34_kernel,@function
k34_kernel:
s_cmp_ge_u32 s2, 256
s_cbranch_scc1 K3_END
s_load_dwordx2 s[4:5], s[0:1], 0
s_load_dwordx2 s[6:7], s[0:1], 88
s_load_dwordx2 s[56:57], s[0:1], 72
v_lshrrev_b32 v1, 6, v0
v_and_b32 v2, 63, v0
v_lshlrev_b32 v3, 4, v2
v_readfirstlane_b32 s3, v1
s_and_b32 s20, s2, 3
s_bfe_u32 s21, s2, 0x30003
s_lshl_b32 s21, s21, 2
s_add_u32 s20, s20, s21
s_and_b32 s21, s2, 4
s_lshr_b32 s22, s2, 6
s_add_u32 s21, s21, s22
v_bfe_u32 v4, v2, 2, 2
v_lshlrev_b32 v4, 9, v4
v_lshrrev_b32 v5, 4, v2
v_lshl_add_u32 v4, v5, 6, v4
v_and_b32 v5, 3, v2
v_lshl_add_u32 v4, v5, 4, v4
s_lshl_b32 s22, s20, 16
s_lshl_b32 s23, s3, 13
s_add_u32 s22, s22, s23
s_add_u32 s22, s22, 0x600000
s_sub_u32 s24, s22, 768
s_add_u32 s25, s22, 4096
s_add_u32 s26, s24, 4096
s_mov_b32 m0, s23
s_getpc_b64 s[16:17]
s_add_u32 s16, s16, TAB_G1@rel32@lo+4
s_addc_u32 s17, s17, TAB_G1@rel32@hi+12
s_mov_b32 s18, 0x2000
s_mov_b32 s19, 0x00020000
s_waitcnt lgkmcnt(0)
s_mov_b32 s12, s6
s_mov_b32 s13, s7
s_mov_b32 s14, 0x2000000
s_mov_b32 s15, 0x00020000
buffer_load_dwordx4 v4, s[12:15], s22 offen offset:0 lds
buffer_load_dwordx4 v4, s[12:15], s24 offen offset:1024 lds
buffer_load_dwordx4 v4, s[12:15], s22 offen offset:2048 lds
buffer_load_dwordx4 v4, s[12:15], s24 offen offset:3072 lds
s_add_u32 s23, s23, 4096
s_mov_b32 m0, s23
s_nop 0
buffer_load_dwordx4 v4, s[12:15], s25 offen offset:0 lds
buffer_load_dwordx4 v4, s[12:15], s26 offen offset:1024 lds
buffer_load_dwordx4 v4, s[12:15], s25 offen offset:2048 lds
buffer_load_dwordx4 v4, s[12:15], s26 offen offset:3072 lds
s_mov_b32 s8, s4
s_mov_b32 s9, s5
s_mov_b32 s10, 0x200000
s_mov_b32 s11, 0x00020000
s_mul_i32 s28, s21, 11
s_lshl_b32 s23, s3, 10
s_add_u32 s24, s23, 132096
s_mov_b32 m0, s24
s_add_u32 s25, s23, 4096
buffer_load_dwordx4 v3, s[16:19], s23 offen lds
s_add_u32 s24, s23, 140288
s_lshl_b32 s26, s28, 8
s_add_u32 s26, s26, s23
s_add_u32 s26, s26, 0x7800
s_add_u32 s27, s23, 144384
s_cmp_ge_u32 s3, 2
s_cmov_b32 s25, s26
s_cmov_b32 s24, s27
s_cmp_lt_u32 s3, 5
s_cbranch_scc0 K3_NOMOD
s_mov_b32 m0, s24
s_nop 0
buffer_load_dwordx4 v3, s[12:15], s25 offen lds
K3_NOMOD:
s_lshl_b32 s23, s3, 18
s_lshl_b32 s24, s20, 10
s_add_u32 s23, s23, s24
s_mul_i32 s24, s3, 8320
s_add_u32 s24, s24, 65536
s_cmp_lt_u32 s3, 4
s_cbranch_scc1 K3_X1
s_mov_b32 m0, s24
s_add_u32 s24, s24, 1040
buffer_load_dwordx4 v3, s[8:11], s23 offen lds
s_add_u32 s23, s23, 0x8000
s_mov_b32 m0, s24
s_add_u32 s24, s24, 1040
buffer_load_dwordx4 v3, s[8:11], s23 offen lds
s_add_u32 s23, s23, 0x8000
s_mov_b32 m0, s24
s_add_u32 s24, s24, 1040
buffer_load_dwordx4 v3, s[8:11], s23 offen lds
s_add_u32 s23, s23, 0x8000
s_mov_b32 m0, s24
s_add_u32 s24, s24, 1040
buffer_load_dwordx4 v3, s[8:11], s23 offen lds
s_add_u32 s23, s23, 0x8000
s_mov_b32 m0, s24
s_add_u32 s24, s24, 1040
buffer_load_dwordx4 v3, s[8:11], s23 offen lds
s_add_u32 s23, s23, 0x8000
s_mov_b32 m0, s24
s_add_u32 s24, s24, 1040
buffer_load_dwordx4 v3, s[8:11], s23 offen lds
s_add_u32 s23, s23, 0x8000
s_mov_b32 m0, s24
s_add_u32 s24, s24, 1040
buffer_load_dwordx4 v3, s[8:11], s23 offen lds
s_add_u32 s23, s23, 0x8000
s_mov_b32 m0, s24
s_add_u32 s24, s24, 1040
buffer_load_dwordx4 v3, s[8:11], s23 offen lds
s_add_u32 s23, s23, 0x8000
K3_X1:
s_add_u32 s28, s28, s3
s_lshl_b32 s30, s28, 15
s_add_u32 s30, s30, 0x800000
s_cmp_lt_u32 s3, 3
s_cselect_b32 s31, 1, 0
s_mov_b32 s29, 8192
s_cmov_b32 s29, 0x40000
s_add_u32 s29, s29, s30
s_add_u32 s32, s30, 0
s_add_u32 s33, s30, 4096
s_add_u32 s34, s30, 8192
s_add_u32 s35, s30, 12288
s_add_u32 s36, s30, 16384
s_add_u32 s37, s30, 20480
s_add_u32 s38, s30, 24576
s_add_u32 s39, s30, 28672
s_add_u32 s40, s29, 0
s_add_u32 s41, s29, 4096
s_add_u32 s42, s29, 8192
s_add_u32 s43, s29, 12288
s_add_u32 s44, s29, 16384
s_add_u32 s45, s29, 20480
s_add_u32 s46, s29, 24576
s_add_u32 s47, s29, 28672
v_and_b32 v8, 3, v2
v_bfe_u32 v9, v2, 2, 2
v_bfe_u32 v10, v2, 4, 1
v_lshrrev_b32 v12, 5, v2
v_and_b32 v11, 1, v8
v_lshl_add_u32 v10, v11, 1, v10
v_lshlrev_b32 v10, 4, v10
v_lshl_add_u32 v10, v1, 8, v10
v_lshl_add_u32 v10, v9, 6, v10
v_lshrrev_b32 v8, 1, v8
v_lshl_add_u32 v10, v8, 3, v10
v_lshl_add_u32 v4, v12, 12, v10
v_add_u32 v5, 132096, v3
s_and_b32 s25, s3, 3
s_lshl_b32 s25, s25, 7
s_lshr_b32 s26, s3, 2
s_lshl_b32 s26, s26, 4
s_add_u32 s25, s25, s26
s_lshl_b32 s26, s25, 1
s_add_u32 s26, s26, 140288
v_lshl_add_u32 v6, v12, 7, s26
v_and_b32 v7, 31, v2
v_mul_u32_u24 v7, 1040, v7
v_lshl_add_u32 v7, v12, 6, v7
s_add_u32 s25, s25, 65536
v_add_u32 v7, s25, v7
v_lshlrev_b32 v8, 3, v2
v_lshl_add_u32 v8, v1, 9, v8
v_add_u32 v8, 142336, v8
v_mov_b32 v9, 0x3f803f80
v_mov_b32 v10, 0
v_mov_b32 v11, 0
v_mov_b32 v12, 0
v_mov_b32 v13, 0
s_mul_i32 s58, s20, 180224
s_add_u32 s58, s58, 0x1000000
s_lshl_b32 s59, s28, 11
s_add_u32 s48, s58, s59
s_add_u32 s49, s48, 0x4000
s_mul_i32 s59, s3, 22528
s_add_u32 s52, s58, s59
s_mul_i32 s53, s21, 180224
s_add_u32 s53, s53, s59
s_add_u32 s53, s53, 0xb00000
s_lshl_b32 s51, s20, 9
s_add_u32 s51, s51, 0x10000
s_cmp_eq_u32 s21, 7
s_cselect_b32 s50, 3, 7
s_cmp_lt_u32 s3, 4
s_cbranch_scc1 K3_X2
s_waitcnt vmcnt(8)
s_branch K3_X3
K3_X2:
s_waitcnt vmcnt(0)
K3_X3:
s_barrier
ds_read_b64_tr_b16 v[80:81], v4 offset:0
ds_read_b64_tr_b16 v[82:83], v4 offset:2048
ds_read_b64_tr_b16 v[84:85], v4 offset:32768
ds_read_b64_tr_b16 v[86:87], v4 offset:34816
ds_read_b128 v[112:115], v5 offset:0
ds_read_b64_tr_b16 v[88:89], v4 offset:8192
ds_read_b64_tr_b16 v[90:91], v4 offset:10240
ds_read_b64_tr_b16 v[92:93], v4 offset:40960
ds_read_b64_tr_b16 v[94:95], v4 offset:43008
ds_read_b128 v[116:119], v5 offset:1024
s_cmp_lt_u32 s3, 4
s_cbranch_scc0 K3_X4
s_mov_b32 m0, s24
s_add_u32 s24, s24, 1040
buffer_load_dwordx4 v3, s[8:11], s23 offen lds
s_add_u32 s23, s23, 0x8000
s_mov_b32 m0, s24
s_add_u32 s24, s24, 1040
buffer_load_dwordx4 v3, s[8:11], s23 offen lds
s_add_u32 s23, s23, 0x8000
s_mov_b32 m0, s24
s_add_u32 s24, s24, 1040
buffer_load_dwordx4 v3, s[8:11], s23 offen lds
s_add_u32 s23, s23, 0x8000
s_mov_b32 m0, s24
s_add_u32 s24, s24, 1040
buffer_load_dwordx4 v3, s[8:11], s23 offen lds
s_add_u32 s23, s23, 0x8000
s_mov_b32 m0, s24
s_add_u32 s24, s24, 1040
buffer_load_dwordx4 v3, s[8:11], s23 offen lds
s_add_u32 s23, s23, 0x8000
s_mov_b32 m0, s24
s_add_u32 s24, s24, 1040
buffer_load_dwordx4 v3, s[8:11], s23 offen lds
s_add_u32 s23, s23, 0x8000
s_mov_b32 m0, s24
s_add_u32 s24, s24, 1040
buffer_load_dwordx4 v3, s[8:11], s23 offen lds
s_add_u32 s23, s23, 0x8000
s_mov_b32 m0, s24
s_add_u32 s24, s24, 1040
buffer_load_dwordx4 v3, s[8:11], s23 offen lds
s_add_u32 s23, s23, 0x8000
K3_X4:
ds_read_b64_tr_b16 v[96:97], v4 offset:16384
ds_read_b64_tr_b16 v[98:99], v4 offset:18432
ds_read_b64_tr_b16 v[100:101], v4 offset:49152
ds_read_b64_tr_b16 v[102:103], v4 offset:51200
ds_read_b128 v[120:123], v5 offset:2048
ds_read_b64_tr_b16 v[104:105], v4 offset:24576
ds_read_b64_tr_b16 v[106:107], v4 offset:26624
ds_read_b64_tr_b16 v[108:109], v4 offset:57344
ds_read_b64_tr_b16 v[110:111], v4 offset:59392
ds_read_b128 v[124:127], v5 offset:3072
s_waitcnt lgkmcnt(15)
v_mfma_f32_32x32x16_bf16 v[16:31], v[80:83], v[112:115], 0
v_mfma_f32_32x32x16_bf16 v[32:47], v[84:87], v[112:115], 0
ds_read_b128 v[208:211], v5 offset:4096
ds_read_b128 v[224:227], v6 offset:0
ds_read_b128 v[228:231], v6 offset:16
buffer_load_dwordx4 v[128:131], v3, s[12:15], s32 offen offset:0
s_waitcnt lgkmcnt(13)
v_mfma_f32_32x32x16_bf16 v[16:31], v[88:91], v[116:119], v[16:31]
v_mfma_f32_32x32x16_bf16 v[32:47], v[92:95], v[116:119], v[32:47]
ds_read_b128 v[212:215], v5 offset:5120
ds_read_b128 v[232:235], v6 offset:64
ds_read_b128 v[236:239], v6 offset:80
buffer_load_dwordx4 v[132:135], v3, s[12:15], s36 offen offset:0
s_waitcnt lgkmcnt(11)
v_mfma_f32_32x32x16_bf16 v[16:31], v[96:99], v[120:123], v[16:31]
v_mfma_f32_32x32x16_bf16 v[32:47], v[100:103], v[120:123], v[32:47]
ds_read_b128 v[216:219], v5 offset:6144
ds_read_b128 v[240:243], v6 offset:1024
ds_read_b128 v[244:247], v6 offset:1040
buffer_load_dwordx4 v[136:139], v3, s[12:15], s40 offen offset:0
s_waitcnt lgkmcnt(9)
v_mfma_f32_32x32x16_bf16 v[16:31], v[104:107], v[124:127], v[16:31]
v_mfma_f32_32x32x16_bf16 v[32:47], v[108:111], v[124:127], v[32:47]
ds_read_b128 v[220:223], v5 offset:7168
ds_read_b128 v[248:251], v6 offset:1088
ds_read_b128 v[252:255], v6 offset:1104
buffer_load_dwordx4 v[140:143], v3, s[12:15], s44 offen offset:0
s_waitcnt vmcnt(4)
s_barrier
ds_read_b128 v[112:115], v7 offset:0
ds_read_b128 v[116:119], v7 offset:512
ds_read_b128 v[120:123], v7 offset:32
ds_read_b128 v[124:127], v7 offset:544
s_waitcnt lgkmcnt(4)
v_mfma_f32_32x32x16_bf16 v[48:63], v[80:83], v[208:211], 0
v_mfma_f32_32x32x16_bf16 v[64:79], v[84:87], v[208:211], 0
v_mov_b32 v4, 0
v_mov_b32 v5, 0
v_mov_b32 v6, 0
v_mov_b32 v2, 0
s_waitcnt lgkmcnt(2)
v_pk_add_f32 v[192:193], v[16:17], v[32:33]
v_pk_add_f32 v[196:197], v[18:19], v[34:35]
v_pk_add_f32 v[200:201], v[20:21], v[36:37]
v_pk_add_f32 v[204:205], v[22:23], v[38:39]
v_pk_add_f32 v[32:33], v[16:17], v[32:33] neg_lo:[0,1] neg_hi:[0,1]
v_pk_add_f32 v[34:35], v[18:19], v[34:35] neg_lo:[0,1] neg_hi:[0,1]
v_pk_add_f32 v[36:37], v[20:21], v[36:37] neg_lo:[0,1] neg_hi:[0,1]
v_pk_add_f32 v[38:39], v[22:23], v[38:39] neg_lo:[0,1] neg_hi:[0,1]
v_lshlrev_b32 v194, 16, v116
v_lshlrev_b32 v198, 16, v117
v_lshlrev_b32 v202, 16, v118
v_lshlrev_b32 v206, 16, v119
v_mfma_f32_32x32x16_bf16 v[48:63], v[88:91], v[212:215], v[48:63]
buffer_load_dwordx4 v[144:147], v3, s[12:15], s32 offen offset:1024
v_and_b32 v195, 0xffff0000, v116
v_and_b32 v199, 0xffff0000, v117
v_and_b32 v203, 0xffff0000, v118
v_and_b32 v207, 0xffff0000, v119
v_lshlrev_b32 v16, 16, v112
v_lshlrev_b32 v18, 16, v113
v_lshlrev_b32 v20, 16, v114
v_lshlrev_b32 v22, 16, v115
v_and_b32 v17, 0xffff0000, v112
v_and_b32 v19, 0xffff0000, v113
v_and_b32 v21, 0xffff0000, v114
v_and_b32 v23, 0xffff0000, v115
v_mfma_f32_32x32x16_bf16 v[64:79], v[92:95], v[212:215], v[64:79]
buffer_load_dwordx4 v[148:151], v3, s[12:15], s36 offen offset:1024
v_pk_fma_f32 v[32:33], v[32:33], v[240:241], v[194:195]
v_pk_fma_f32 v[34:35], v[34:35], v[242:243], v[198:199]
v_pk_fma_f32 v[36:37], v[36:37], v[244:245], v[202:203]
v_pk_fma_f32 v[38:39], v[38:39], v[246:247], v[206:207]
v_pk_fma_f32 v[16:17], v[192:193], v[224:225], v[16:17]
v_pk_fma_f32 v[18:19], v[196:197], v[226:227], v[18:19]
v_pk_fma_f32 v[20:21], v[200:201], v[228:229], v[20:21]
v_pk_fma_f32 v[22:23], v[204:205], v[230:231], v[22:23]
v_cvt_pk_bf16_f32 v116, v32, v33
v_cvt_pk_bf16_f32 v117, v34, v35
v_cvt_pk_bf16_f32 v118, v36, v37
v_cvt_pk_bf16_f32 v119, v38, v39
v_cvt_pk_bf16_f32 v112, v16, v17
v_cvt_pk_bf16_f32 v113, v18, v19
v_cvt_pk_bf16_f32 v114, v20, v21
v_cvt_pk_bf16_f32 v115, v22, v23
v_mfma_f32_32x32x16_bf16 v[48:63], v[96:99], v[216:219], v[48:63]
buffer_load_dwordx4 v[152:155], v3, s[12:15], s40 offen offset:1024
v_dot2c_f32_bf16 v10, v116, v9
v_dot2c_f32_bf16 v4, v117, v9
v_dot2c_f32_bf16 v10, v118, v9
v_dot2c_f32_bf16 v4, v119, v9
v_dot2c_f32_bf16 v11, v116, v116
v_dot2c_f32_bf16 v5, v117, v117
v_dot2c_f32_bf16 v11, v118, v118
v_dot2c_f32_bf16 v5, v119, v119
v_dot2c_f32_bf16 v10, v112, v9
v_dot2c_f32_bf16 v4, v113, v9
v_dot2c_f32_bf16 v10, v114, v9
v_dot2c_f32_bf16 v4, v115, v9
v_dot2c_f32_bf16 v11, v112, v112
v_dot2c_f32_bf16 v5, v113, v113
v_dot2c_f32_bf16 v11, v114, v114
v_dot2c_f32_bf16 v5, v115, v115
v_mfma_f32_32x32x16_bf16 v[64:79], v[100:103], v[216:219], v[64:79]
buffer_load_dwordx4 v[156:159], v3, s[12:15], s44 offen offset:1024
ds_write_b128 v7, v[112:115] offset:0
ds_write_b128 v7, v[116:119] offset:512
ds_read_b128 v[112:115], v7 offset:33280
ds_read_b128 v[116:119], v7 offset:33792
s_waitcnt lgkmcnt(4)
v_pk_add_f32 v[192:193], v[24:25], v[40:41]
v_pk_add_f32 v[196:197], v[26:27], v[42:43]
v_pk_add_f32 v[200:201], v[28:29], v[44:45]
v_pk_add_f32 v[204:205], v[30:31], v[46:47]
v_pk_add_f32 v[40:41], v[24:25], v[40:41] neg_lo:[0,1] neg_hi:[0,1]
v_pk_add_f32 v[42:43], v[26:27], v[42:43] neg_lo:[0,1] neg_hi:[0,1]
v_pk_add_f32 v[44:45], v[28:29], v[44:45] neg_lo:[0,1] neg_hi:[0,1]
v_pk_add_f32 v[46:47], v[30:31], v[46:47] neg_lo:[0,1] neg_hi:[0,1]
v_lshlrev_b32 v194, 16, v124
v_lshlrev_b32 v198, 16, v125
v_lshlrev_b32 v202, 16, v126
v_lshlrev_b32 v206, 16, v127
v_mfma_f32_32x32x16_bf16 v[48:63], v[104:107], v[220:223], v[48:63]
buffer_load_dwordx4 v[160:163], v3, s[12:15], s32 offen offset:2048
v_and_b32 v195, 0xffff0000, v124
v_and_b32 v199, 0xffff0000, v125
v_and_b32 v203, 0xffff0000, v126
v_and_b32 v207, 0xffff0000, v127
v_lshlrev_b32 v24, 16, v120
v_lshlrev_b32 v26, 16, v121
v_lshlrev_b32 v28, 16, v122
v_lshlrev_b32 v30, 16, v123
v_and_b32 v25, 0xffff0000, v120
v_and_b32 v27, 0xffff0000, v121
v_and_b32 v29, 0xffff0000, v122
v_and_b32 v31, 0xffff0000, v123
v_mfma_f32_32x32x16_bf16 v[64:79], v[108:111], v[220:223], v[64:79]
buffer_load_dwordx4 v[164:167], v3, s[12:15], s36 offen offset:2048
v_pk_fma_f32 v[40:41], v[40:41], v[248:249], v[194:195]
v_pk_fma_f32 v[42:43], v[42:43], v[250:251], v[198:199]
v_pk_fma_f32 v[44:45], v[44:45], v[252:253], v[202:203]
v_pk_fma_f32 v[46:47], v[46:47], v[254:255], v[206:207]
v_pk_fma_f32 v[24:25], v[192:193], v[232:233], v[24:25]
v_pk_fma_f32 v[26:27], v[196:197], v[234:235], v[26:27]
v_pk_fma_f32 v[28:29], v[200:201], v[236:237], v[28:29]
v_pk_fma_f32 v[30:31], v[204:205], v[238:239], v[30:31]
v_cvt_pk_bf16_f32 v124, v40, v41
v_cvt_pk_bf16_f32 v125, v42, v43
v_cvt_pk_bf16_f32 v126, v44, v45
v_cvt_pk_bf16_f32 v127, v46, v47
v_cvt_pk_bf16_f32 v120, v24, v25
v_cvt_pk_bf16_f32 v121, v26, v27
v_cvt_pk_bf16_f32 v122, v28, v29
v_cvt_pk_bf16_f32 v123, v30, v31
buffer_load_dwordx4 v[168:171], v3, s[12:15], s40 offen offset:2048
v_dot2c_f32_bf16 v10, v124, v9
v_dot2c_f32_bf16 v4, v125, v9
v_dot2c_f32_bf16 v10, v126, v9
v_dot2c_f32_bf16 v4, v127, v9
v_dot2c_f32_bf16 v11, v124, v124
v_dot2c_f32_bf16 v5, v125, v125
v_dot2c_f32_bf16 v11, v126, v126
v_dot2c_f32_bf16 v5, v127, v127
v_dot2c_f32_bf16 v10, v120, v9
v_dot2c_f32_bf16 v4, v121, v9
v_dot2c_f32_bf16 v10, v122, v9
v_dot2c_f32_bf16 v4, v123, v9
v_dot2c_f32_bf16 v11, v120, v120
v_dot2c_f32_bf16 v5, v121, v121
v_dot2c_f32_bf16 v11, v122, v122
v_dot2c_f32_bf16 v5, v123, v123
buffer_load_dwordx4 v[172:175], v3, s[12:15], s44 offen offset:2048
ds_write_b128 v7, v[120:123] offset:32
ds_write_b128 v7, v[124:127] offset:544
ds_read_b128 v[120:123], v7 offset:33312
ds_read_b128 v[124:127], v7 offset:33824
s_waitcnt lgkmcnt(4)
v_pk_add_f32 v[80:81], v[48:49], v[64:65]
v_pk_add_f32 v[84:85], v[50:51], v[66:67]
v_pk_add_f32 v[88:89], v[52:53], v[68:69]
v_pk_add_f32 v[92:93], v[54:55], v[70:71]
v_pk_add_f32 v[64:65], v[48:49], v[64:65] neg_lo:[0,1] neg_hi:[0,1]
v_pk_add_f32 v[66:67], v[50:51], v[66:67] neg_lo:[0,1] neg_hi:[0,1]
v_pk_add_f32 v[68:69], v[52:53], v[68:69] neg_lo:[0,1] neg_hi:[0,1]
v_pk_add_f32 v[70:71], v[54:55], v[70:71] neg_lo:[0,1] neg_hi:[0,1]
v_lshlrev_b32 v82, 16, v116
v_lshlrev_b32 v86, 16, v117
v_lshlrev_b32 v90, 16, v118
v_lshlrev_b32 v94, 16, v119
buffer_load_dwordx4 v[176:179], v3, s[12:15], s32 offen offset:3072
v_and_b32 v83, 0xffff0000, v116
v_and_b32 v87, 0xffff0000, v117
v_and_b32 v91, 0xffff0000, v118
v_and_b32 v95, 0xffff0000, v119
v_lshlrev_b32 v48, 16, v112
v_lshlrev_b32 v50, 16, v113
v_lshlrev_b32 v52, 16, v114
v_lshlrev_b32 v54, 16, v115
v_and_b32 v49, 0xffff0000, v112
v_and_b32 v51, 0xffff0000, v113
v_and_b32 v53, 0xffff0000, v114
v_and_b32 v55, 0xffff0000, v115
buffer_load_dwordx4 v[180:183], v3, s[12:15], s36 offen offset:3072
v_pk_fma_f32 v[64:65], v[64:65], v[240:241], v[82:83]
v_pk_fma_f32 v[66:67], v[66:67], v[242:243], v[86:87]
v_pk_fma_f32 v[68:69], v[68:69], v[244:245], v[90:91]
v_pk_fma_f32 v[70:71], v[70:71], v[246:247], v[94:95]
v_pk_fma_f32 v[48:49], v[80:81], v[224:225], v[48:49]
v_pk_fma_f32 v[50:51], v[84:85], v[226:227], v[50:51]
v_pk_fma_f32 v[52:53], v[88:89], v[228:229], v[52:53]
v_pk_fma_f32 v[54:55], v[92:93], v[230:231], v[54:55]
v_cvt_pk_bf16_f32 v116, v64, v65
v_cvt_pk_bf16_f32 v117, v66, v67
v_cvt_pk_bf16_f32 v118, v68, v69
v_cvt_pk_bf16_f32 v119, v70, v71
v_cvt_pk_bf16_f32 v112, v48, v49
v_cvt_pk_bf16_f32 v113, v50, v51
v_cvt_pk_bf16_f32 v114, v52, v53
v_cvt_pk_bf16_f32 v115, v54, v55
buffer_load_dwordx4 v[184:187], v3, s[12:15], s40 offen offset:3072
v_dot2c_f32_bf16 v12, v116, v9
v_dot2c_f32_bf16 v6, v117, v9
v_dot2c_f32_bf16 v12, v118, v9
v_dot2c_f32_bf16 v6, v119, v9
v_dot2c_f32_bf16 v13, v116, v116
v_dot2c_f32_bf16 v2, v117, v117
v_dot2c_f32_bf16 v13, v118, v118
v_dot2c_f32_bf16 v2, v119, v119
v_dot2c_f32_bf16 v12, v112, v9
v_dot2c_f32_bf16 v6, v113, v9
v_dot2c_f32_bf16 v12, v114, v9
v_dot2c_f32_bf16 v6, v115, v9
v_dot2c_f32_bf16 v13, v112, v112
v_dot2c_f32_bf16 v2, v113, v113
v_dot2c_f32_bf16 v13, v114, v114
v_dot2c_f32_bf16 v2, v115, v115
buffer_load_dwordx4 v[188:191], v3, s[12:15], s44 offen offset:3072
s_cmp_eq_u32 s31, 1
s_cbranch_scc0 K3_Y8
buffer_load_dwordx4 v[192:195], v3, s[12:15], s33 offen offset:0
buffer_load_dwordx4 v[196:199], v3, s[12:15], s37 offen offset:0
K3_Y8:
ds_write_b128 v7, v[112:115] offset:33280
ds_write_b128 v7, v[116:119] offset:33792
s_waitcnt lgkmcnt(2)
v_pk_add_f32 v[80:81], v[56:57], v[72:73]
v_pk_add_f32 v[84:85], v[58:59], v[74:75]
v_pk_add_f32 v[88:89], v[60:61], v[76:77]
v_pk_add_f32 v[92:93], v[62:63], v[78:79]
v_pk_add_f32 v[72:73], v[56:57], v[72:73] neg_lo:[0,1] neg_hi:[0,1]
v_pk_add_f32 v[74:75], v[58:59], v[74:75] neg_lo:[0,1] neg_hi:[0,1]
v_pk_add_f32 v[76:77], v[60:61], v[76:77] neg_lo:[0,1] neg_hi:[0,1]
v_pk_add_f32 v[78:79], v[62:63], v[78:79] neg_lo:[0,1] neg_hi:[0,1]
v_lshlrev_b32 v82, 16, v124
v_lshlrev_b32 v86, 16, v125
v_lshlrev_b32 v90, 16, v126
v_lshlrev_b32 v94, 16, v127
s_cmp_eq_u32 s31, 1
s_cbranch_scc0 K3_Y6
buffer_load_dwordx4 v[200:203], v3, s[12:15], s41 offen offset:0
buffer_load_dwordx4 v[204:207], v3, s[12:15], s45 offen offset:0
K3_Y6:
v_and_b32 v83, 0xffff0000, v124
v_and_b32 v87, 0xffff0000, v125
v_and_b32 v91, 0xffff0000, v126
v_and_b32 v95, 0xffff0000, v127
v_lshlrev_b32 v56, 16, v120
v_lshlrev_b32 v58, 16, v121
v_lshlrev_b32 v60, 16, v122
v_lshlrev_b32 v62, 16, v123
v_and_b32 v57, 0xffff0000, v120
v_and_b32 v59, 0xffff0000, v121
v_and_b32 v61, 0xffff0000, v122
v_and_b32 v63, 0xffff0000, v123
s_cmp_eq_u32 s31, 1
s_cbranch_scc0 K3_Y4
buffer_load_dwordx4 v[208:211], v3, s[12:15], s33 offen offset:1024
buffer_load_dwordx4 v[212:215], v3, s[12:15], s37 offen offset:1024
K3_Y4:
v_pk_fma_f32 v[72:73], v[72:73], v[248:249], v[82:83]
v_pk_fma_f32 v[74:75], v[74:75], v[250:251], v[86:87]
v_pk_fma_f32 v[76:77], v[76:77], v[252:253], v[90:91]
v_pk_fma_f32 v[78:79], v[78:79], v[254:255], v[94:95]
v_pk_fma_f32 v[56:57], v[80:81], v[232:233], v[56:57]
v_pk_fma_f32 v[58:59], v[84:85], v[234:235], v[58:59]
v_pk_fma_f32 v[60:61], v[88:89], v[236:237], v[60:61]
v_pk_fma_f32 v[62:63], v[92:93], v[238:239], v[62:63]
v_cvt_pk_bf16_f32 v124, v72, v73
v_cvt_pk_bf16_f32 v125, v74, v75
v_cvt_pk_bf16_f32 v126, v76, v77
v_cvt_pk_bf16_f32 v127, v78, v79
v_cvt_pk_bf16_f32 v120, v56, v57
v_cvt_pk_bf16_f32 v121, v58, v59
v_cvt_pk_bf16_f32 v122, v60, v61
v_cvt_pk_bf16_f32 v123, v62, v63
s_cmp_eq_u32 s31, 1
s_cbranch_scc0 K3_Y2
buffer_load_dwordx4 v[216:219], v3, s[12:15], s41 offen offset:1024
buffer_load_dwordx4 v[220:223], v3, s[12:15], s45 offen offset:1024
K3_Y2:
v_dot2c_f32_bf16 v12, v124, v9
v_dot2c_f32_bf16 v6, v125, v9
v_dot2c_f32_bf16 v12, v126, v9
v_dot2c_f32_bf16 v6, v127, v9
v_dot2c_f32_bf16 v13, v124, v124
v_dot2c_f32_bf16 v2, v125, v125
v_dot2c_f32_bf16 v13, v126, v126
v_dot2c_f32_bf16 v2, v127, v127
v_dot2c_f32_bf16 v12, v120, v9
v_dot2c_f32_bf16 v6, v121, v9
v_dot2c_f32_bf16 v12, v122, v9
v_dot2c_f32_bf16 v6, v123, v9
v_dot2c_f32_bf16 v13, v120, v120
v_dot2c_f32_bf16 v2, v121, v121
v_dot2c_f32_bf16 v13, v122, v122
v_dot2c_f32_bf16 v2, v123, v123
ds_write_b128 v7, v[120:123] offset:33312
ds_write_b128 v7, v[124:127] offset:33824
v_add_f32 v10, v10, v4
v_add_f32 v11, v11, v5
v_add_f32 v12, v12, v6
v_add_f32 v13, v13, v2
v_lshrrev_b32 v2, 4, v3
v_permlane32_swap_b32 v10, v12
v_permlane32_swap_b32 v11, v13
v_add_f32 v10, v10, v12
v_add_f32 v11, v11, v13
ds_write_b64 v8, v[10:11]
v_and_b32 v4, 31, v2
v_mul_u32_u24 v4, 1040, v4
v_lshrrev_b32 v5, 5, v2
v_lshl_add_u32 v4, v5, 4, v4
v_add_u32 v4, 65536, v4
v_lshlrev_b32 v7, 3, v2
v_add_u32 v7, 142336, v7
s_lshl_b32 s22, s3, 8
s_add_u32 s22, s22, 146432
v_lshl_add_u32 v9, v5, 4, s22
s_mov_b32 s26, s51
s_and_b32 s23, s3, 1
s_lshl_b32 s23, s23, 8
v_xor_b32 v10, s23, v3
s_bfe_u32 s23, s3, 0x10001
s_lshl_b32 s23, s23, 10
v_add_u32 v11, s23, v10
v_xor_b32 v10, 0x400, v11
s_cmp_eq_u32 s31, 1
s_waitcnt lgkmcnt(0)
s_barrier
s_cmp_eq_u32 s31, 1
s_cbranch_scc0 K3_M1
ds_read_b128 v[80:83], v4 offset:0
ds_read_b128 v[84:87], v4 offset:33280
ds_read_b128 v[88:91], v4 offset:32
ds_read_b128 v[92:95], v4 offset:33312
buffer_load_dwordx4 v[224:227], v3, s[12:15], s33 offen offset:2048
buffer_load_dwordx4 v[228:231], v3, s[12:15], s37 offen offset:2048
ds_read_b128 v[96:99], v4 offset:64
ds_read_b128 v[100:103], v4 offset:33344
ds_read_b128 v[104:107], v4 offset:96
ds_read_b128 v[108:111], v4 offset:33376
s_waitcnt vmcnt(22)
s_waitcnt lgkmcnt(4)
v_mfma_f32_32x32x16_bf16 v[16:31], v[128:131], v[80:83], 0
v_mfma_f32_32x32x16_bf16 v[48:63], v[136:139], v[80:83], 0
buffer_load_dwordx4 v[232:235], v3, s[12:15], s41 offen offset:2048
buffer_load_dwordx4 v[236:239], v3, s[12:15], s45 offen offset:2048
v_mfma_f32_32x32x16_bf16 v[32:47], v[128:131], v[84:87], 0
v_mfma_f32_32x32x16_bf16 v[64:79], v[136:139], v[84:87], 0
buffer_load_dwordx4 v[240:243], v3, s[12:15], s33 offen offset:3072
buffer_load_dwordx4 v[244:247], v3, s[12:15], s37 offen offset:3072
v_mfma_f32_32x32x16_bf16 v[16:31], v[132:135], v[88:91], v[16:31]
v_mfma_f32_32x32x16_bf16 v[48:63], v[140:143], v[88:91], v[48:63]
buffer_load_dwordx4 v[248:251], v3, s[12:15], s41 offen offset:3072
buffer_load_dwordx4 v[252:255], v3, s[12:15], s45 offen offset:3072
v_mfma_f32_32x32x16_bf16 v[32:47], v[132:135], v[92:95], v[32:47]
v_mfma_f32_32x32x16_bf16 v[64:79], v[140:143], v[92:95], v[64:79]
buffer_load_dwordx4 v[112:115], v3, s[12:15], s34 offen offset:0
buffer_load_dwordx4 v[116:119], v3, s[12:15], s38 offen offset:0
ds_read_b128 v[80:83], v4 offset:128
ds_read_b128 v[84:87], v4 offset:33408
ds_read_b128 v[88:91], v4 offset:160
ds_read_b128 v[92:95], v4 offset:33440
s_waitcnt vmcnt(26)
s_waitcnt lgkmcnt(4)
v_mfma_f32_32x32x16_bf16 v[16:31], v[144:147], v[96:99], v[16:31]
v_mfma_f32_32x32x16_bf16 v[48:63], v[152:155], v[96:99], v[48:63]
buffer_load_dwordx4 v[120:123], v3, s[12:15], s42 offen offset:0
buffer_load_dwordx4 v[124:127], v3, s[12:15], s46 offen offset:0
v_mfma_f32_32x32x16_bf16 v[32:47], v[144:147], v[100:103], v[32:47]
v_mfma_f32_32x32x16_bf16 v[64:79], v[152:155], v[100:103], v[64:79]
buffer_load_dwordx4 v[128:131], v3, s[12:15], s34 offen offset:1024
buffer_load_dwordx4 v[132:135], v3, s[12:15], s38 offen offset:1024
v_mfma_f32_32x32x16_bf16 v[16:31], v[148:151], v[104:107], v[16:31]
v_mfma_f32_32x32x16_bf16 v[48:63], v[156:159], v[104:107], v[48:63]
buffer_load_dwordx4 v[136:139], v3, s[12:15], s42 offen offset:1024
buffer_load_dwordx4 v[140:143], v3, s[12:15], s46 offen offset:1024
v_mfma_f32_32x32x16_bf16 v[32:47], v[148:151], v[108:111], v[32:47]
v_mfma_f32_32x32x16_bf16 v[64:79], v[156:159], v[108:111], v[64:79]
buffer_load_dwordx4 v[144:147], v3, s[12:15], s34 offen offset:2048
buffer_load_dwordx4 v[148:151], v3, s[12:15], s38 offen offset:2048
ds_read_b128 v[96:99], v4 offset:192
ds_read_b128 v[100:103], v4 offset:33472
ds_read_b128 v[104:107], v4 offset:224
ds_read_b128 v[108:111], v4 offset:33504
s_waitcnt vmcnt(30)
s_waitcnt lgkmcnt(4)
v_mfma_f32_32x32x16_bf16 v[16:31], v[160:163], v[80:83], v[16:31]
v_mfma_f32_32x32x16_bf16 v[48:63], v[168:171], v[80:83], v[48:63]
buffer_load_dwordx4 v[152:155], v3, s[12:15], s42 offen offset:2048
buffer_load_dwordx4 v[156:159], v3, s[12:15], s46 offen offset:2048
v_mfma_f32_32x32x16_bf16 v[32:47], v[160:163], v[84:87], v[32:47]
v_mfma_f32_32x32x16_bf16 v[64:79], v[168:171], v[84:87], v[64:79]
v_mfma_f32_32x32x16_bf16 v[16:31], v[164:167], v[88:91], v[16:31]
v_mfma_f32_32x32x16_bf16 v[48:63], v[172:175], v[88:91], v[48:63]
v_mfma_f32_32x32x16_bf16 v[32:47], v[164:167], v[92:95], v[32:47]
v_mfma_f32_32x32x16_bf16 v[64:79], v[172:175], v[92:95], v[64:79]
buffer_load_dwordx4 v[160:163], v3, s[12:15], s34 offen offset:3072
buffer_load_dwordx4 v[164:167], v3, s[12:15], s38 offen offset:3072
ds_read_b128 v[80:83], v4 offset:256
ds_read_b128 v[84:87], v4 offset:33536
ds_read_b128 v[88:91], v4 offset:288
ds_read_b128 v[92:95], v4 offset:33568
s_waitcnt vmcnt(30)
s_waitcnt lgkmcnt(4)
v_mfma_f32_32x32x16_bf16 v[16:31], v[176:179], v[96:99], v[16:31]
v_mfma_f32_32x32x16_bf16 v[48:63], v[184:187], v[96:99], v[48:63]
buffer_load_dwordx4 v[168:171], v3, s[12:15], s42 offen offset:3072
buffer_load_dwordx4 v[172:175], v3, s[12:15], s46 offen offset:3072
v_mfma_f32_32x32x16_bf16 v[32:47], v[176:179], v[100:103], v[32:47]
v_mfma_f32_32x32x16_bf16 v[64:79], v[184:187], v[100:103], v[64:79]
v_mfma_f32_32x32x16_bf16 v[16:31], v[180:183], v[104:107], v[16:31]
v_mfma_f32_32x32x16_bf16 v[48:63], v[188:191], v[104:107], v[48:63]
v_mfma_f32_32x32x16_bf16 v[32:47], v[180:183], v[108:111], v[32:47]
v_mfma_f32_32x32x16_bf16 v[64:79], v[188:191], v[108:111], v[64:79]
buffer_load_dwordx4 v[176:179], v3, s[12:15], s35 offen offset:0
buffer_load_dwordx4 v[180:183], v3, s[12:15], s39 offen offset:0
ds_read_b128 v[96:99], v4 offset:320
ds_read_b128 v[100:103], v4 offset:33600
ds_read_b128 v[104:107], v4 offset:352
ds_read_b128 v[108:111], v4 offset:33632
s_waitcnt vmcnt(30)
s_waitcnt lgkmcnt(4)
v_mfma_f32_32x32x16_bf16 v[16:31], v[192:195], v[80:83], v[16:31]
v_mfma_f32_32x32x16_bf16 v[48:63], v[200:203], v[80:83], v[48:63]
buffer_load_dwordx4 v[184:187], v3, s[12:15], s43 offen offset:0
buffer_load_dwordx4 v[188:191], v3, s[12:15], s47 offen offset:0
v_mfma_f32_32x32x16_bf16 v[32:47], v[192:195], v[84:87], v[32:47]
v_mfma_f32_32x32x16_bf16 v[64:79], v[200:203], v[84:87], v[64:79]
v_mfma_f32_32x32x16_bf16 v[16:31], v[196:199], v[88:91], v[16:31]
v_mfma_f32_32x32x16_bf16 v[48:63], v[204:207], v[88:91], v[48:63]
v_mfma_f32_32x32x16_bf16 v[32:47], v[196:199], v[92:95], v[32:47]
v_mfma_f32_32x32x16_bf16 v[64:79], v[204:207], v[92:95], v[64:79]
buffer_load_dwordx4 v[192:195], v3, s[12:15], s35 offen offset:1024
buffer_load_dwordx4 v[196:199], v3, s[12:15], s39 offen offset:1024
ds_read_b128 v[80:83], v4 offset:384
ds_read_b128 v[84:87], v4 offset:33664
ds_read_b128 v[88:91], v4 offset:416
ds_read_b128 v[92:95], v4 offset:33696
s_waitcnt vmcnt(30)
s_waitcnt lgkmcnt(4)
v_mfma_f32_32x32x16_bf16 v[16:31], v[208:211], v[96:99], v[16:31]
v_mfma_f32_32x32x16_bf16 v[48:63], v[216:219], v[96:99], v[48:63]
buffer_load_dwordx4 v[200:203], v3, s[12:15], s43 offen offset:1024
buffer_load_dwordx4 v[204:207], v3, s[12:15], s47 offen offset:1024
v_mfma_f32_32x32x16_bf16 v[32:47], v[208:211], v[100:103], v[32:47]
v_mfma_f32_32x32x16_bf16 v[64:79], v[216:219], v[100:103], v[64:79]
v_mfma_f32_32x32x16_bf16 v[16:31], v[212:215], v[104:107], v[16:31]
v_mfma_f32_32x32x16_bf16 v[48:63], v[220:223], v[104:107], v[48:63]
v_mfma_f32_32x32x16_bf16 v[32:47], v[212:215], v[108:111], v[32:47]
v_mfma_f32_32x32x16_bf16 v[64:79], v[220:223], v[108:111], v[64:79]
buffer_load_dwordx4 v[208:211], v3, s[12:15], s35 offen offset:2048
buffer_load_dwordx4 v[212:215], v3, s[12:15], s39 offen offset:2048
ds_read_b128 v[96:99], v4 offset:448
ds_read_b128 v[100:103], v4 offset:33728
ds_read_b128 v[104:107], v4 offset:480
ds_read_b128 v[108:111], v4 offset:33760
s_waitcnt vmcnt(30)
s_waitcnt lgkmcnt(4)
v_mfma_f32_32x32x16_bf16 v[16:31], v[224:227], v[80:83], v[16:31]
v_mfma_f32_32x32x16_bf16 v[48:63], v[232:235], v[80:83], v[48:63]
buffer_load_dwordx4 v[216:219], v3, s[12:15], s43 offen offset:2048
buffer_load_dwordx4 v[220:223], v3, s[12:15], s47 offen offset:2048
v_mfma_f32_32x32x16_bf16 v[32:47], v[224:227], v[84:87], v[32:47]
v_mfma_f32_32x32x16_bf16 v[64:79], v[232:235], v[84:87], v[64:79]
v_mfma_f32_32x32x16_bf16 v[16:31], v[228:231], v[88:91], v[16:31]
v_mfma_f32_32x32x16_bf16 v[48:63], v[236:239], v[88:91], v[48:63]
v_mfma_f32_32x32x16_bf16 v[32:47], v[228:231], v[92:95], v[32:47]
v_mfma_f32_32x32x16_bf16 v[64:79], v[236:239], v[92:95], v[64:79]
buffer_load_dwordx4 v[224:227], v3, s[12:15], s35 offen offset:3072
buffer_load_dwordx4 v[228:231], v3, s[12:15], s39 offen offset:3072
ds_read_b128 v[80:83], v4 offset:512
ds_read_b128 v[84:87], v4 offset:33792
ds_read_b128 v[88:91], v4 offset:544
ds_read_b128 v[92:95], v4 offset:33824
s_waitcnt vmcnt(30)
s_waitcnt lgkmcnt(4)
v_mfma_f32_32x32x16_bf16 v[16:31], v[240:243], v[96:99], v[16:31]
v_mfma_f32_32x32x16_bf16 v[48:63], v[248:251], v[96:99], v[48:63]
buffer_load_dwordx4 v[232:235], v3, s[12:15], s43 offen offset:3072
buffer_load_dwordx4 v[236:239], v3, s[12:15], s47 offen offset:3072
v_mfma_f32_32x32x16_bf16 v[32:47], v[240:243], v[100:103], v[32:47]
v_mfma_f32_32x32x16_bf16 v[64:79], v[248:251], v[100:103], v[64:79]
v_mfma_f32_32x32x16_bf16 v[16:31], v[244:247], v[104:107], v[16:31]
v_mfma_f32_32x32x16_bf16 v[48:63], v[252:255], v[104:107], v[48:63]
v_mfma_f32_32x32x16_bf16 v[32:47], v[244:247], v[108:111], v[32:47]
v_mfma_f32_32x32x16_bf16 v[64:79], v[252:255], v[108:111], v[64:79]
s_add_u32 s54, s53, 0
buffer_load_dwordx4 v[240:243], v11, s[12:15], s54 offen offset:0
buffer_load_dwordx4 v[244:247], v10, s[12:15], s54 offen offset:0
ds_read_b128 v[96:99], v4 offset:576
ds_read_b128 v[100:103], v4 offset:33856
ds_read_b128 v[104:107], v4 offset:608
ds_read_b128 v[108:111], v4 offset:33888
s_waitcnt vmcnt(30)
s_waitcnt lgkmcnt(4)
v_mfma_f32_32x32x16_bf16 v[16:31], v[112:115], v[80:83], v[16:31]
v_mfma_f32_32x32x16_bf16 v[48:63], v[120:123], v[80:83], v[48:63]
buffer_load_dwordx4 v[248:251], v11, s[12:15], s54 offen offset:2048
buffer_load_dwordx4 v[252:255], v10, s[12:15], s54 offen offset:2048
v_mfma_f32_32x32x16_bf16 v[32:47], v[112:115], v[84:87], v[32:47]
v_mfma_f32_32x32x16_bf16 v[64:79], v[120:123], v[84:87], v[64:79]
v_mfma_f32_32x32x16_bf16 v[16:31], v[116:119], v[88:91], v[16:31]
v_mfma_f32_32x32x16_bf16 v[48:63], v[124:127], v[88:91], v[48:63]
v_mfma_f32_32x32x16_bf16 v[32:47], v[116:119], v[92:95], v[32:47]
v_mfma_f32_32x32x16_bf16 v[64:79], v[124:127], v[92:95], v[64:79]
ds_read_b128 v[80:83], v4 offset:640
ds_read_b128 v[84:87], v4 offset:33920
ds_read_b128 v[88:91], v4 offset:672
ds_read_b128 v[92:95], v4 offset:33952
s_waitcnt vmcnt(28)
s_waitcnt lgkmcnt(4)
v_mfma_f32_32x32x16_bf16 v[16:31], v[128:131], v[96:99], v[16:31]
v_mfma_f32_32x32x16_bf16 v[48:63], v[136:139], v[96:99], v[48:63]
v_mfma_f32_32x32x16_bf16 v[32:47], v[128:131], v[100:103], v[32:47]
v_mfma_f32_32x32x16_bf16 v[64:79], v[136:139], v[100:103], v[64:79]
v_mfma_f32_32x32x16_bf16 v[16:31], v[132:135], v[104:107], v[16:31]
v_mfma_f32_32x32x16_bf16 v[48:63], v[140:143], v[104:107], v[48:63]
v_mfma_f32_32x32x16_bf16 v[32:47], v[132:135], v[108:111], v[32:47]
v_mfma_f32_32x32x16_bf16 v[64:79], v[140:143], v[108:111], v[64:79]
s_add_u32 s54, s53, 4096
buffer_load_dwordx4 v[128:131], v11, s[12:15], s54 offen offset:0
buffer_load_dwordx4 v[132:135], v10, s[12:15], s54 offen offset:0
ds_read_b128 v[96:99], v4 offset:704
ds_read_b128 v[100:103], v4 offset:33984
ds_read_b128 v[104:107], v4 offset:736
ds_read_b128 v[108:111], v4 offset:34016
ds_read_b64 v[112:113], v7 offset:0
ds_read_b64 v[114:115], v7 offset:512
ds_read_b64 v[116:117], v7 offset:1024
ds_read_b64 v[118:119], v7 offset:1536
ds_read_b64 v[120:121], v7 offset:2048
ds_read_b64 v[122:123], v7 offset:2560
ds_read_b64 v[124:125], v7 offset:3072
ds_read_b64 v[126:127], v7 offset:3584
s_waitcnt vmcnt(26)
s_waitcnt lgkmcnt(12)
v_mfma_f32_32x32x16_bf16 v[16:31], v[144:147], v[80:83], v[16:31]
v_mfma_f32_32x32x16_bf16 v[48:63], v[152:155], v[80:83], v[48:63]
buffer_load_dwordx4 v[136:139], v11, s[12:15], s54 offen offset:2048
buffer_load_dwordx4 v[140:143], v10, s[12:15], s54 offen offset:2048
v_mfma_f32_32x32x16_bf16 v[32:47], v[144:147], v[84:87], v[32:47]
v_mfma_f32_32x32x16_bf16 v[64:79], v[152:155], v[84:87], v[64:79]
v_mfma_f32_32x32x16_bf16 v[16:31], v[148:151], v[88:91], v[16:31]
v_mfma_f32_32x32x16_bf16 v[48:63], v[156:159], v[88:91], v[48:63]
v_mfma_f32_32x32x16_bf16 v[32:47], v[148:151], v[92:95], v[32:47]
v_mfma_f32_32x32x16_bf16 v[64:79], v[156:159], v[92:95], v[64:79]
s_add_u32 s54, s53, 8192
buffer_load_dwordx4 v[144:147], v11, s[12:15], s54 offen offset:0
buffer_load_dwordx4 v[148:151], v10, s[12:15], s54 offen offset:0
ds_read_b128 v[80:83], v4 offset:768
ds_read_b128 v[84:87], v4 offset:34048
ds_read_b128 v[88:91], v4 offset:800
ds_read_b128 v[92:95], v4 offset:34080
s_waitcnt vmcnt(26)
s_waitcnt lgkmcnt(12)
v_mfma_f32_32x32x16_bf16 v[16:31], v[160:163], v[96:99], v[16:31]
v_mfma_f32_32x32x16_bf16 v[48:63], v[168:171], v[96:99], v[48:63]
buffer_load_dwordx4 v[152:155], v11, s[12:15], s54 offen offset:2048
buffer_load_dwordx4 v[156:159], v10, s[12:15], s54 offen offset:2048
v_mfma_f32_32x32x16_bf16 v[32:47], v[160:163], v[100:103], v[32:47]
v_mfma_f32_32x32x16_bf16 v[64:79], v[168:171], v[100:103], v[64:79]
v_mfma_f32_32x32x16_bf16 v[16:31], v[164:167], v[104:107], v[16:31]
v_mfma_f32_32x32x16_bf16 v[48:63], v[172:175], v[104:107], v[48:63]
v_mfma_f32_32x32x16_bf16 v[32:47], v[164:167], v[108:111], v[32:47]
v_mfma_f32_32x32x16_bf16 v[64:79], v[172:175], v[108:111], v[64:79]
s_add_u32 s54, s53, 12288
buffer_load_dwordx4 v[160:163], v11, s[12:15], s54 offen offset:0
buffer_load_dwordx4 v[164:167], v10, s[12:15], s54 offen offset:0
ds_read_b128 v[96:99], v4 offset:832
ds_read_b128 v[100:103], v4 offset:34112
ds_read_b128 v[104:107], v4 offset:864
ds_read_b128 v[108:111], v4 offset:34144
s_waitcnt vmcnt(26)
s_waitcnt lgkmcnt(4)
v_mfma_f32_32x32x16_bf16 v[16:31], v[176:179], v[80:83], v[16:31]
v_pk_add_f32 v[112:113], v[112:113], v[114:115]
v_pk_add_f32 v[116:117], v[116:117], v[118:119]
v_pk_add_f32 v[120:121], v[120:121], v[122:123]
v_pk_add_f32 v[124:125], v[124:125], v[126:127]
v_mfma_f32_32x32x16_bf16 v[48:63], v[184:187], v[80:83], v[48:63]
v_pk_add_f32 v[112:113], v[112:113], v[116:117]
v_pk_add_f32 v[120:121], v[120:121], v[124:125]
v_pk_add_f32 v[112:113], v[112:113], v[120:121]
v_mul_f32 v12, 0x3b000000, v112
buffer_load_dwordx4 v[168:171], v11, s[12:15], s54 offen offset:2048
buffer_load_dwordx4 v[172:175], v10, s[12:15], s54 offen offset:2048
v_mfma_f32_32x32x16_bf16 v[32:47], v[176:179], v[84:87], v[32:47]
v_mul_f32 v13, 0x3b000000, v113
v_fma_f32 v13, -v12, v12, v13
v_max_f32 v13, 0, v13
v_cvt_pk_bf16_f32 v14, v12, v13
v_mfma_f32_32x32x16_bf16 v[64:79], v[184:187], v[84:87], v[64:79]
v_lshlrev_b32 v12, 16, v14
v_and_b32 v13, 0xffff0000, v14
v_add_f32 v13, 0x3727c5ac, v13
v_cvt_pk_bf16_f32 v13, v13, v13
v_mfma_f32_32x32x16_bf16 v[16:31], v[180:183], v[88:91], v[16:31]
v_lshlrev_b32 v13, 16, v13
v_sqrt_f32 v13, v13
s_nop 0
v_cvt_pk_bf16_f32 v13, v13, v13
v_lshlrev_b32 v13, 16, v13
v_mfma_f32_32x32x16_bf16 v[48:63], v[188:191], v[88:91], v[48:63]
v_rcp_f32 v13, v13
s_nop 0
v_mul_f32 v12, v12, v13
v_sub_f32 v12, 0, v12
v_mov_b32 v15, v13
v_mfma_f32_32x32x16_bf16 v[32:47], v[180:183], v[92:95], v[32:47]
v_mov_b32 v14, v12
v_permlane32_swap_b32 v13, v15
s_nop 0
v_permlane32_swap_b32 v12, v14
v_mfma_f32_32x32x16_bf16 v[64:79], v[188:191], v[92:95], v[64:79]
s_add_u32 s54, s53, 16384
buffer_load_dwordx4 v[176:179], v11, s[12:15], s54 offen offset:0
buffer_load_dwordx4 v[180:183], v10, s[12:15], s54 offen offset:0
ds_read_b128 v[80:83], v4 offset:896
ds_read_b128 v[84:87], v4 offset:34176
ds_read_b128 v[88:91], v4 offset:928
ds_read_b128 v[92:95], v4 offset:34208
s_waitcnt vmcnt(26)
s_waitcnt lgkmcnt(4)
v_mfma_f32_32x32x16_bf16 v[16:31], v[192:195], v[96:99], v[16:31]
v_mfma_f32_32x32x16_bf16 v[48:63], v[200:203], v[96:99], v[48:63]
buffer_load_dwordx4 v[184:187], v11, s[12:15], s54 offen offset:2048
buffer_load_dwordx4 v[188:191], v10, s[12:15], s54 offen offset:2048
v_mfma_f32_32x32x16_bf16 v[32:47], v[192:195], v[100:103], v[32:47]
v_mfma_f32_32x32x16_bf16 v[64:79], v[200:203], v[100:103], v[64:79]
v_mfma_f32_32x32x16_bf16 v[16:31], v[196:199], v[104:107], v[16:31]
v_mfma_f32_32x32x16_bf16 v[48:63], v[204:207], v[104:107], v[48:63]
v_mfma_f32_32x32x16_bf16 v[32:47], v[196:199], v[108:111], v[32:47]
v_mfma_f32_32x32x16_bf16 v[64:79], v[204:207], v[108:111], v[64:79]
s_add_u32 s54, s53, 20480
buffer_load_dwordx4 v[192:195], v11, s[12:15], s54 offen offset:0
buffer_load_dwordx4 v[196:199], v10, s[12:15], s54 offen offset:0
ds_read_b128 v[96:99], v4 offset:960
ds_read_b128 v[100:103], v4 offset:34240
ds_read_b128 v[104:107], v4 offset:992
ds_read_b128 v[108:111], v4 offset:34272
s_waitcnt vmcnt(26)
s_waitcnt lgkmcnt(4)
v_mfma_f32_32x32x16_bf16 v[16:31], v[208:211], v[80:83], v[16:31]
v_mfma_f32_32x32x16_bf16 v[48:63], v[216:219], v[80:83], v[48:63]
v_mfma_f32_32x32x16_bf16 v[32:47], v[208:211], v[84:87], v[32:47]
v_mfma_f32_32x32x16_bf16 v[64:79], v[216:219], v[84:87], v[64:79]
v_mfma_f32_32x32x16_bf16 v[16:31], v[212:215], v[88:91], v[16:31]
v_mfma_f32_32x32x16_bf16 v[48:63], v[220:223], v[88:91], v[48:63]
v_mfma_f32_32x32x16_bf16 v[32:47], v[212:215], v[92:95], v[32:47]
v_mfma_f32_32x32x16_bf16 v[64:79], v[220:223], v[92:95], v[64:79]
s_waitcnt vmcnt(22)
s_waitcnt lgkmcnt(0)
v_mfma_f32_32x32x16_bf16 v[16:31], v[224:227], v[96:99], v[16:31]
v_mfma_f32_32x32x16_bf16 v[48:63], v[232:235], v[96:99], v[48:63]
v_mfma_f32_32x32x16_bf16 v[32:47], v[224:227], v[100:103], v[32:47]
v_mfma_f32_32x32x16_bf16 v[64:79], v[232:235], v[100:103], v[64:79]
v_mfma_f32_32x32x16_bf16 v[16:31], v[228:231], v[104:107], v[16:31]
v_mfma_f32_32x32x16_bf16 v[48:63], v[236:239], v[104:107], v[48:63]
v_mfma_f32_32x32x16_bf16 v[32:47], v[228:231], v[108:111], v[32:47]
v_mfma_f32_32x32x16_bf16 v[64:79], v[236:239], v[108:111], v[64:79]
s_lshl_b32 s27, s3, 11
v_add_u32 v6, s27, v3
ds_read_b128 v[80:83], v9 offset:0
ds_read_b128 v[84:87], v9 offset:32
ds_read_b128 v[88:91], v9 offset:64
ds_read_b128 v[92:95], v9 offset:96
ds_read_b128 v[96:99], v9 offset:128
ds_read_b128 v[100:103], v9 offset:160
ds_read_b128 v[104:107], v9 offset:192
ds_read_b128 v[108:111], v9 offset:224
s_waitcnt lgkmcnt(0)
v_fma_f32 v16, v16, v13, v88
v_fma_f32 v17, v17, v13, v89
v_fma_f32 v18, v18, v13, v90
v_fma_f32 v19, v19, v13, v91
v_fma_f32 v20, v20, v13, v92
v_fma_f32 v21, v21, v13, v93
v_fma_f32 v22, v22, v13, v94
v_fma_f32 v23, v23, v13, v95
v_fma_f32 v16, v80, v12, v16
v_fma_f32 v17, v81, v12, v17
v_fma_f32 v18, v82, v12, v18
v_fma_f32 v19, v83, v12, v19
v_fma_f32 v20, v84, v12, v20
v_fma_f32 v21, v85, v12, v21
v_fma_f32 v22, v86, v12, v22
v_fma_f32 v23, v87, v12, v23
v_fma_f32 v24, v24, v13, v104
v_fma_f32 v25, v25, v13, v105
v_fma_f32 v26, v26, v13, v106
v_fma_f32 v27, v27, v13, v107
v_fma_f32 v28, v28, v13, v108
v_fma_f32 v29, v29, v13, v109
v_fma_f32 v30, v30, v13, v110
v_fma_f32 v31, v31, v13, v111
v_fma_f32 v24, v96, v12, v24
v_fma_f32 v25, v97, v12, v25
v_fma_f32 v26, v98, v12, v26
v_fma_f32 v27, v99, v12, v27
v_fma_f32 v28, v100, v12, v28
v_fma_f32 v29, v101, v12, v29
v_fma_f32 v30, v102, v12, v30
v_fma_f32 v31, v103, v12, v31
v_mul_f32 v16, v16, v24
v_mul_f32 v17, v17, v25
v_mul_f32 v18, v18, v26
v_mul_f32 v19, v19, v27
v_mul_f32 v20, v20, v28
v_mul_f32 v21, v21, v29
v_mul_f32 v22, v22, v30
v_mul_f32 v23, v23, v31
v_cvt_pk_bf16_f32 v112, v16, v17
v_cvt_pk_bf16_f32 v113, v18, v19
v_cvt_pk_bf16_f32 v114, v20, v21
v_cvt_pk_bf16_f32 v115, v22, v23
buffer_store_dwordx4 v[112:115], v3, s[12:15], s48 offen offset:0 sc1
ds_write_b128 v6, v[112:115] offset:0
v_fma_f32 v32, v32, v15, v88
v_fma_f32 v33, v33, v15, v89
v_fma_f32 v34, v34, v15, v90
v_fma_f32 v35, v35, v15, v91
v_fma_f32 v36, v36, v15, v92
v_fma_f32 v37, v37, v15, v93
v_fma_f32 v38, v38, v15, v94
v_fma_f32 v39, v39, v15, v95
v_fma_f32 v32, v80, v14, v32
v_fma_f32 v33, v81, v14, v33
v_fma_f32 v34, v82, v14, v34
v_fma_f32 v35, v83, v14, v35
v_fma_f32 v36, v84, v14, v36
v_fma_f32 v37, v85, v14, v37
v_fma_f32 v38, v86, v14, v38
v_fma_f32 v39, v87, v14, v39
v_fma_f32 v40, v40, v15, v104
v_fma_f32 v41, v41, v15, v105
v_fma_f32 v42, v42, v15, v106
v_fma_f32 v43, v43, v15, v107
v_fma_f32 v44, v44, v15, v108
v_fma_f32 v45, v45, v15, v109
v_fma_f32 v46, v46, v15, v110
v_fma_f32 v47, v47, v15, v111
v_fma_f32 v40, v96, v14, v40
v_fma_f32 v41, v97, v14, v41
v_fma_f32 v42, v98, v14, v42
v_fma_f32 v43, v99, v14, v43
v_fma_f32 v44, v100, v14, v44
v_fma_f32 v45, v101, v14, v45
v_fma_f32 v46, v102, v14, v46
v_fma_f32 v47, v103, v14, v47
v_mul_f32 v32, v32, v40
v_mul_f32 v33, v33, v41
v_mul_f32 v34, v34, v42
v_mul_f32 v35, v35, v43
v_mul_f32 v36, v36, v44
v_mul_f32 v37, v37, v45
v_mul_f32 v38, v38, v46
v_mul_f32 v39, v39, v47
v_cvt_pk_bf16_f32 v116, v32, v33
v_cvt_pk_bf16_f32 v117, v34, v35
v_cvt_pk_bf16_f32 v118, v36, v37
v_cvt_pk_bf16_f32 v119, v38, v39
buffer_store_dwordx4 v[116:119], v3, s[12:15], s48 offen offset:1024 sc1
ds_write_b128 v6, v[116:119] offset:1024
ds_read_b128 v[80:83], v9 offset:2048
ds_read_b128 v[84:87], v9 offset:2080
ds_read_b128 v[88:91], v9 offset:2112
ds_read_b128 v[92:95], v9 offset:2144
ds_read_b128 v[96:99], v9 offset:2176
ds_read_b128 v[100:103], v9 offset:2208
ds_read_b128 v[104:107], v9 offset:2240
ds_read_b128 v[108:111], v9 offset:2272
s_waitcnt lgkmcnt(0)
v_fma_f32 v48, v48, v13, v88
v_fma_f32 v49, v49, v13, v89
v_fma_f32 v50, v50, v13, v90
v_fma_f32 v51, v51, v13, v91
v_fma_f32 v52, v52, v13, v92
v_fma_f32 v53, v53, v13, v93
v_fma_f32 v54, v54, v13, v94
v_fma_f32 v55, v55, v13, v95
v_fma_f32 v48, v80, v12, v48
v_fma_f32 v49, v81, v12, v49
v_fma_f32 v50, v82, v12, v50
v_fma_f32 v51, v83, v12, v51
v_fma_f32 v52, v84, v12, v52
v_fma_f32 v53, v85, v12, v53
v_fma_f32 v54, v86, v12, v54
v_fma_f32 v55, v87, v12, v55
v_fma_f32 v56, v56, v13, v104
v_fma_f32 v57, v57, v13, v105
v_fma_f32 v58, v58, v13, v106
v_fma_f32 v59, v59, v13, v107
v_fma_f32 v60, v60, v13, v108
v_fma_f32 v61, v61, v13, v109
v_fma_f32 v62, v62, v13, v110
v_fma_f32 v63, v63, v13, v111
v_fma_f32 v56, v96, v12, v56
v_fma_f32 v57, v97, v12, v57
v_fma_f32 v58, v98, v12, v58
v_fma_f32 v59, v99, v12, v59
v_fma_f32 v60, v100, v12, v60
v_fma_f32 v61, v101, v12, v61
v_fma_f32 v62, v102, v12, v62
v_fma_f32 v63, v103, v12, v63
v_mul_f32 v48, v48, v56
v_mul_f32 v49, v49, v57
v_mul_f32 v50, v50, v58
v_mul_f32 v51, v51, v59
v_mul_f32 v52, v52, v60
v_mul_f32 v53, v53, v61
v_mul_f32 v54, v54, v62
v_mul_f32 v55, v55, v63
v_cvt_pk_bf16_f32 v120, v48, v49
v_cvt_pk_bf16_f32 v121, v50, v51
v_cvt_pk_bf16_f32 v122, v52, v53
v_cvt_pk_bf16_f32 v123, v54, v55
buffer_store_dwordx4 v[120:123], v3, s[12:15], s49 offen offset:0 sc1
ds_write_b128 v6, v[120:123] offset:16384
v_fma_f32 v64, v64, v15, v88
v_fma_f32 v65, v65, v15, v89
v_fma_f32 v66, v66, v15, v90
v_fma_f32 v67, v67, v15, v91
v_fma_f32 v68, v68, v15, v92
v_fma_f32 v69, v69, v15, v93
v_fma_f32 v70, v70, v15, v94
v_fma_f32 v71, v71, v15, v95
v_fma_f32 v64, v80, v14, v64
v_fma_f32 v65, v81, v14, v65
v_fma_f32 v66, v82, v14, v66
v_fma_f32 v67, v83, v14, v67
v_fma_f32 v68, v84, v14, v68
v_fma_f32 v69, v85, v14, v69
v_fma_f32 v70, v86, v14, v70
v_fma_f32 v71, v87, v14, v71
v_fma_f32 v72, v72, v15, v104
v_fma_f32 v73, v73, v15, v105
v_fma_f32 v74, v74, v15, v106
v_fma_f32 v75, v75, v15, v107
v_fma_f32 v76, v76, v15, v108
v_fma_f32 v77, v77, v15, v109
v_fma_f32 v78, v78, v15, v110
v_fma_f32 v79, v79, v15, v111
v_fma_f32 v72, v96, v14, v72
v_fma_f32 v73, v97, v14, v73
v_fma_f32 v74, v98, v14, v74
v_fma_f32 v75, v99, v14, v75
v_fma_f32 v76, v100, v14, v76
v_fma_f32 v77, v101, v14, v77
v_fma_f32 v78, v102, v14, v78
v_fma_f32 v79, v103, v14, v79
v_mul_f32 v64, v64, v72
v_mul_f32 v65, v65, v73
v_mul_f32 v66, v66, v74
v_mul_f32 v67, v67, v75
v_mul_f32 v68, v68, v76
v_mul_f32 v69, v69, v77
v_mul_f32 v70, v70, v78
v_mul_f32 v71, v71, v79
v_cvt_pk_bf16_f32 v124, v64, v65
v_cvt_pk_bf16_f32 v125, v66, v67
v_cvt_pk_bf16_f32 v126, v68, v69
v_cvt_pk_bf16_f32 v127, v70, v71
buffer_store_dwordx4 v[124:127], v3, s[12:15], s49 offen offset:1024 sc1
ds_write_b128 v6, v[124:127] offset:17408
s_lshr_b32 s24, s3, 2
v_and_b32 v7, 31, v2
s_lshl_b32 s25, s24, 5
v_add_u32 v7, s25, v7
v_mul_u32_u24 v8, 1040, v7
v_lshl_add_u32 v8, v5, 4, v8
s_and_b32 s25, s3, 3
s_lshl_b32 s25, s25, 5
s_lshl_b32 s27, s21, 7
s_add_u32 s25, s25, s27
s_add_u32 s27, s25, 65536
v_add_u32 v8, s27, v8
ds_read_b128 v[12:15], v8
v_lshlrev_b32 v7, 15, v7
v_lshl_add_u32 v7, v5, 4, v7
s_lshl_b32 s27, s20, 10
s_add_u32 s29, s25, s27
s_lshl_b32 s30, s25, 1
s_add_u32 s30, s30, 10240
v_lshlrev_b32 v6, 5, v5
s_lshl_b32 s25, s24, 10
v_add_u32 v8, s25, v3
v_xor_b32 v9, 0x400, v8
s_mov_b32 s8, s56
s_mov_b32 s9, s57
s_lshl_b32 s27, s21, 2
v_mov_b32 v0, s27
v_mov_b32 v1, 1
s_lshl_b32 s27, s3, 2
v_mov_b32 v4, s27
s_waitcnt vmcnt(0)
s_waitcnt lgkmcnt(0)
s_barrier
s_cmp_eq_u32 s3, s21
s_cbranch_scc0 K3_NO2
ds_read_b128 v[80:83], v8 offset:0
ds_read_b128 v[84:87], v9 offset:0
ds_read_b128 v[88:91], v8 offset:2048
ds_read_b128 v[92:95], v9 offset:2048
ds_read_b128 v[96:99], v8 offset:4096
ds_read_b128 v[100:103], v9 offset:4096
ds_read_b128 v[104:107], v8 offset:6144
ds_read_b128 v[108:111], v9 offset:6144
ds_read_b128 v[112:115], v8 offset:8192
ds_read_b128 v[116:119], v9 offset:8192
ds_read_b128 v[120:123], v8 offset:10240
ds_read_b128 v[124:127], v9 offset:10240
ds_read_b128 v[200:203], v8 offset:12288
ds_read_b128 v[204:207], v9 offset:12288
ds_read_b128 v[208:211], v8 offset:14336
ds_read_b128 v[212:215], v9 offset:14336
ds_read_b128 v[216:219], v8 offset:16384
ds_read_b128 v[220:223], v9 offset:16384
ds_read_b128 v[224:227], v8 offset:18432
ds_read_b128 v[228:231], v9 offset:18432
ds_read_b128 v[232:235], v8 offset:20480
ds_read_b128 v[236:239], v9 offset:20480
s_waitcnt lgkmcnt(0)
K3_NO2:
s_barrier
s_cmp_eq_u32 s3, s21
s_cbranch_scc0 K3_NL2
s_waitcnt vmcnt(0)
v_mfma_f32_32x32x16_bf16 v[16:31], v[240:243], v[80:83], 0
v_mfma_f32_32x32x16_bf16 v[32:47], v[244:247], v[80:83], 0
v_mfma_f32_32x32x16_bf16 v[48:63], v[240:243], v[84:87], 0
v_mfma_f32_32x32x16_bf16 v[64:79], v[244:247], v[84:87], 0
v_mfma_f32_32x32x16_bf16 v[16:31], v[248:251], v[88:91], v[16:31]
v_mfma_f32_32x32x16_bf16 v[32:47], v[252:255], v[88:91], v[32:47]
v_mfma_f32_32x32x16_bf16 v[48:63], v[248:251], v[92:95], v[48:63]
v_mfma_f32_32x32x16_bf16 v[64:79], v[252:255], v[92:95], v[64:79]
v_mfma_f32_32x32x16_bf16 v[16:31], v[128:131], v[96:99], v[16:31]
v_mfma_f32_32x32x16_bf16 v[32:47], v[132:135], v[96:99], v[32:47]
v_mfma_f32_32x32x16_bf16 v[48:63], v[128:131], v[100:103], v[48:63]
v_mfma_f32_32x32x16_bf16 v[64:79], v[132:135], v[100:103], v[64:79]
v_mfma_f32_32x32x16_bf16 v[16:31], v[136:139], v[104:107], v[16:31]
v_mfma_f32_32x32x16_bf16 v[32:47], v[140:143], v[104:107], v[32:47]
v_mfma_f32_32x32x16_bf16 v[48:63], v[136:139], v[108:111], v[48:63]
v_mfma_f32_32x32x16_bf16 v[64:79], v[140:143], v[108:111], v[64:79]
v_mfma_f32_32x32x16_bf16 v[16:31], v[144:147], v[112:115], v[16:31]
v_mfma_f32_32x32x16_bf16 v[32:47], v[148:151], v[112:115], v[32:47]
v_mfma_f32_32x32x16_bf16 v[48:63], v[144:147], v[116:119], v[48:63]
v_mfma_f32_32x32x16_bf16 v[64:79], v[148:151], v[116:119], v[64:79]
v_mfma_f32_32x32x16_bf16 v[16:31], v[152:155], v[120:123], v[16:31]
v_mfma_f32_32x32x16_bf16 v[32:47], v[156:159], v[120:123], v[32:47]
v_mfma_f32_32x32x16_bf16 v[48:63], v[152:155], v[124:127], v[48:63]
v_mfma_f32_32x32x16_bf16 v[64:79], v[156:159], v[124:127], v[64:79]
v_mfma_f32_32x32x16_bf16 v[16:31], v[160:163], v[200:203], v[16:31]
v_mfma_f32_32x32x16_bf16 v[32:47], v[164:167], v[200:203], v[32:47]
v_mfma_f32_32x32x16_bf16 v[48:63], v[160:163], v[204:207], v[48:63]
v_mfma_f32_32x32x16_bf16 v[64:79], v[164:167], v[204:207], v[64:79]
v_mfma_f32_32x32x16_bf16 v[16:31], v[168:171], v[208:211], v[16:31]
v_mfma_f32_32x32x16_bf16 v[32:47], v[172:175], v[208:211], v[32:47]
v_mfma_f32_32x32x16_bf16 v[48:63], v[168:171], v[212:215], v[48:63]
v_mfma_f32_32x32x16_bf16 v[64:79], v[172:175], v[212:215], v[64:79]
v_mfma_f32_32x32x16_bf16 v[16:31], v[176:179], v[216:219], v[16:31]
v_mfma_f32_32x32x16_bf16 v[32:47], v[180:183], v[216:219], v[32:47]
v_mfma_f32_32x32x16_bf16 v[48:63], v[176:179], v[220:223], v[48:63]
v_mfma_f32_32x32x16_bf16 v[64:79], v[180:183], v[220:223], v[64:79]
v_mfma_f32_32x32x16_bf16 v[16:31], v[184:187], v[224:227], v[16:31]
v_mfma_f32_32x32x16_bf16 v[32:47], v[188:191], v[224:227], v[32:47]
v_mfma_f32_32x32x16_bf16 v[48:63], v[184:187], v[228:231], v[48:63]
v_mfma_f32_32x32x16_bf16 v[64:79], v[188:191], v[228:231], v[64:79]
v_mfma_f32_32x32x16_bf16 v[16:31], v[192:195], v[232:235], v[16:31]
v_mfma_f32_32x32x16_bf16 v[32:47], v[196:199], v[232:235], v[32:47]
v_mfma_f32_32x32x16_bf16 v[48:63], v[192:195], v[236:239], v[48:63]
v_mfma_f32_32x32x16_bf16 v[64:79], v[196:199], v[236:239], v[64:79]
buffer_load_dwordx4 v[80:83], v6, s[12:15], s30 offen
buffer_load_dwordx4 v[84:87], v6, s[12:15], s30 offen offset:16
s_nop 9
s_branch K3_RED
K3_NL2:
s_add_u32 s55, s52, 0
buffer_load_dwordx4 v[80:83], v8, s[12:15], s55 offen offset:0 sc1
buffer_load_dwordx4 v[84:87], v9, s[12:15], s55 offen offset:0 sc1
buffer_load_dwordx4 v[88:91], v8, s[12:15], s55 offen offset:2048 sc1
buffer_load_dwordx4 v[92:95], v9, s[12:15], s55 offen offset:2048 sc1
s_add_u32 s55, s52, 4096
buffer_load_dwordx4 v[96:99], v8, s[12:15], s55 offen offset:0 sc1
buffer_load_dwordx4 v[100:103], v9, s[12:15], s55 offen offset:0 sc1
buffer_load_dwordx4 v[104:107], v8, s[12:15], s55 offen offset:2048 sc1
buffer_load_dwordx4 v[108:111], v9, s[12:15], s55 offen offset:2048 sc1
s_waitcnt vmcnt(6)
v_mfma_f32_32x32x16_bf16 v[16:31], v[240:243], v[80:83], 0
v_mfma_f32_32x32x16_bf16 v[32:47], v[244:247], v[80:83], 0
v_mfma_f32_32x32x16_bf16 v[48:63], v[240:243], v[84:87], 0
v_mfma_f32_32x32x16_bf16 v[64:79], v[244:247], v[84:87], 0
s_add_u32 s55, s52, 8192
buffer_load_dwordx4 v[112:115], v8, s[12:15], s55 offen offset:0 sc1
buffer_load_dwordx4 v[116:119], v9, s[12:15], s55 offen offset:0 sc1
s_waitcnt vmcnt(6)
v_mfma_f32_32x32x16_bf16 v[16:31], v[248:251], v[88:91], v[16:31]
v_mfma_f32_32x32x16_bf16 v[32:47], v[252:255], v[88:91], v[32:47]
v_mfma_f32_32x32x16_bf16 v[48:63], v[248:251], v[92:95], v[48:63]
v_mfma_f32_32x32x16_bf16 v[64:79], v[252:255], v[92:95], v[64:79]
buffer_load_dwordx4 v[120:123], v8, s[12:15], s55 offen offset:2048 sc1
buffer_load_dwordx4 v[124:127], v9, s[12:15], s55 offen offset:2048 sc1
s_waitcnt vmcnt(6)
v_mfma_f32_32x32x16_bf16 v[16:31], v[128:131], v[96:99], v[16:31]
v_mfma_f32_32x32x16_bf16 v[32:47], v[132:135], v[96:99], v[32:47]
v_mfma_f32_32x32x16_bf16 v[48:63], v[128:131], v[100:103], v[48:63]
v_mfma_f32_32x32x16_bf16 v[64:79], v[132:135], v[100:103], v[64:79]
s_add_u32 s55, s52, 12288
buffer_load_dwordx4 v[200:203], v8, s[12:15], s55 offen offset:0 sc1
buffer_load_dwordx4 v[204:207], v9, s[12:15], s55 offen offset:0 sc1
s_waitcnt vmcnt(6)
v_mfma_f32_32x32x16_bf16 v[16:31], v[136:139], v[104:107], v[16:31]
v_mfma_f32_32x32x16_bf16 v[32:47], v[140:143], v[104:107], v[32:47]
v_mfma_f32_32x32x16_bf16 v[48:63], v[136:139], v[108:111], v[48:63]
v_mfma_f32_32x32x16_bf16 v[64:79], v[140:143], v[108:111], v[64:79]
buffer_load_dwordx4 v[208:211], v8, s[12:15], s55 offen offset:2048 sc1
buffer_load_dwordx4 v[212:215], v9, s[12:15], s55 offen offset:2048 sc1
s_waitcnt vmcnt(6)
v_mfma_f32_32x32x16_bf16 v[16:31], v[144:147], v[112:115], v[16:31]
v_mfma_f32_32x32x16_bf16 v[32:47], v[148:151], v[112:115], v[32:47]
v_mfma_f32_32x32x16_bf16 v[48:63], v[144:147], v[116:119], v[48:63]
v_mfma_f32_32x32x16_bf16 v[64:79], v[148:151], v[116:119], v[64:79]
s_add_u32 s55, s52, 16384
buffer_load_dwordx4 v[216:219], v8, s[12:15], s55 offen offset:0 sc1
buffer_load_dwordx4 v[220:223], v9, s[12:15], s55 offen offset:0 sc1
s_waitcnt vmcnt(6)
v_mfma_f32_32x32x16_bf16 v[16:31], v[152:155], v[120:123], v[16:31]
v_mfma_f32_32x32x16_bf16 v[32:47], v[156:159], v[120:123], v[32:47]
v_mfma_f32_32x32x16_bf16 v[48:63], v[152:155], v[124:127], v[48:63]
v_mfma_f32_32x32x16_bf16 v[64:79], v[156:159], v[124:127], v[64:79]
buffer_load_dwordx4 v[224:227], v8, s[12:15], s55 offen offset:2048 sc1
buffer_load_dwordx4 v[228:231], v9, s[12:15], s55 offen offset:2048 sc1
s_waitcnt vmcnt(6)
v_mfma_f32_32x32x16_bf16 v[16:31], v[160:163], v[200:203], v[16:31]
v_mfma_f32_32x32x16_bf16 v[32:47], v[164:167], v[200:203], v[32:47]
v_mfma_f32_32x32x16_bf16 v[48:63], v[160:163], v[204:207], v[48:63]
v_mfma_f32_32x32x16_bf16 v[64:79], v[164:167], v[204:207], v[64:79]
s_add_u32 s55, s52, 20480
buffer_load_dwordx4 v[232:235], v8, s[12:15], s55 offen offset:0 sc1
buffer_load_dwordx4 v[236:239], v9, s[12:15], s55 offen offset:0 sc1
s_waitcnt vmcnt(6)
v_mfma_f32_32x32x16_bf16 v[16:31], v[168:171], v[208:211], v[16:31]
v_mfma_f32_32x32x16_bf16 v[32:47], v[172:175], v[208:211], v[32:47]
v_mfma_f32_32x32x16_bf16 v[48:63], v[168:171], v[212:215], v[48:63]
v_mfma_f32_32x32x16_bf16 v[64:79], v[172:175], v[212:215], v[64:79]
buffer_load_dwordx4 v[80:83], v6, s[12:15], s30 offen
buffer_load_dwordx4 v[84:87], v6, s[12:15], s30 offen offset:16
s_waitcnt vmcnt(6)
v_mfma_f32_32x32x16_bf16 v[16:31], v[176:179], v[216:219], v[16:31]
v_mfma_f32_32x32x16_bf16 v[32:47], v[180:183], v[216:219], v[32:47]
v_mfma_f32_32x32x16_bf16 v[48:63], v[176:179], v[220:223], v[48:63]
v_mfma_f32_32x32x16_bf16 v[64:79], v[180:183], v[220:223], v[64:79]
s_waitcnt vmcnt(4)
v_mfma_f32_32x32x16_bf16 v[16:31], v[184:187], v[224:227], v[16:31]
v_mfma_f32_32x32x16_bf16 v[32:47], v[188:191], v[224:227], v[32:47]
v_mfma_f32_32x32x16_bf16 v[48:63], v[184:187], v[228:231], v[48:63]
v_mfma_f32_32x32x16_bf16 v[64:79], v[188:191], v[228:231], v[64:79]
s_waitcnt vmcnt(2)
v_mfma_f32_32x32x16_bf16 v[16:31], v[192:195], v[232:235], v[16:31]
v_mfma_f32_32x32x16_bf16 v[32:47], v[196:199], v[232:235], v[32:47]
v_mfma_f32_32x32x16_bf16 v[48:63], v[192:195], v[236:239], v[48:63]
v_mfma_f32_32x32x16_bf16 v[64:79], v[196:199], v[236:239], v[64:79]
s_nop 11
s_branch K3_RED
K3_M1:
ds_read_b128 v[80:83], v4 offset:0
ds_read_b128 v[84:87], v4 offset:33280
ds_read_b128 v[88:91], v4 offset:32
ds_read_b128 v[92:95], v4 offset:33312
ds_read_b128 v[96:99], v4 offset:512
ds_read_b128 v[100:103], v4 offset:33792
ds_read_b128 v[104:107], v4 offset:544
ds_read_b128 v[108:111], v4 offset:33824
s_waitcnt vmcnt(12)
s_waitcnt lgkmcnt(4)
v_mfma_f32_32x32x16_bf16 v[16:31], v[128:131], v[80:83], 0
v_mfma_f32_32x32x16_bf16 v[32:47], v[128:131], v[84:87], 0
v_mfma_f32_32x32x16_bf16 v[16:31], v[132:135], v[88:91], v[16:31]
v_mfma_f32_32x32x16_bf16 v[32:47], v[132:135], v[92:95], v[32:47]
ds_read_b128 v[80:83], v4 offset:64
ds_read_b128 v[84:87], v4 offset:33344
ds_read_b128 v[88:91], v4 offset:96
ds_read_b128 v[92:95], v4 offset:33376
s_waitcnt vmcnt(12)
s_waitcnt lgkmcnt(4)
v_mfma_f32_32x32x16_bf16 v[16:31], v[136:139], v[96:99], v[16:31]
v_mfma_f32_32x32x16_bf16 v[32:47], v[136:139], v[100:103], v[32:47]
v_mfma_f32_32x32x16_bf16 v[16:31], v[140:143], v[104:107], v[16:31]
v_mfma_f32_32x32x16_bf16 v[32:47], v[140:143], v[108:111], v[32:47]
ds_read_b128 v[96:99], v4 offset:576
ds_read_b128 v[100:103], v4 offset:33856
ds_read_b128 v[104:107], v4 offset:608
ds_read_b128 v[108:111], v4 offset:33888
s_waitcnt vmcnt(8)
s_waitcnt lgkmcnt(4)
v_mfma_f32_32x32x16_bf16 v[16:31], v[144:147], v[80:83], v[16:31]
v_mfma_f32_32x32x16_bf16 v[32:47], v[144:147], v[84:87], v[32:47]
v_mfma_f32_32x32x16_bf16 v[16:31], v[148:151], v[88:91], v[16:31]
v_mfma_f32_32x32x16_bf16 v[32:47], v[148:151], v[92:95], v[32:47]
ds_read_b128 v[80:83], v4 offset:128
ds_read_b128 v[84:87], v4 offset:33408
ds_read_b128 v[88:91], v4 offset:160
ds_read_b128 v[92:95], v4 offset:33440
s_waitcnt vmcnt(8)
s_waitcnt lgkmcnt(4)
v_mfma_f32_32x32x16_bf16 v[16:31], v[152:155], v[96:99], v[16:31]
buffer_load_dwordx4 v[192:195], v3, s[12:15], s33 offen offset:0
v_mfma_f32_32x32x16_bf16 v[32:47], v[152:155], v[100:103], v[32:47]
v_mfma_f32_32x32x16_bf16 v[16:31], v[156:159], v[104:107], v[16:31]
buffer_load_dwordx4 v[196:199], v3, s[12:15], s37 offen offset:0
v_mfma_f32_32x32x16_bf16 v[32:47], v[156:159], v[108:111], v[32:47]
ds_read_b128 v[96:99], v4 offset:640
ds_read_b128 v[100:103], v4 offset:33920
ds_read_b128 v[104:107], v4 offset:672
ds_read_b128 v[108:111], v4 offset:33952
s_waitcnt vmcnt(6)
s_waitcnt lgkmcnt(4)
v_mfma_f32_32x32x16_bf16 v[16:31], v[160:163], v[80:83], v[16:31]
buffer_load_dwordx4 v[200:203], v3, s[12:15], s41 offen offset:0
v_mfma_f32_32x32x16_bf16 v[32:47], v[160:163], v[84:87], v[32:47]
v_mfma_f32_32x32x16_bf16 v[16:31], v[164:167], v[88:91], v[16:31]
buffer_load_dwordx4 v[204:207], v3, s[12:15], s45 offen offset:0
v_mfma_f32_32x32x16_bf16 v[32:47], v[164:167], v[92:95], v[32:47]
ds_read_b128 v[80:83], v4 offset:192
ds_read_b128 v[84:87], v4 offset:33472
ds_read_b128 v[88:91], v4 offset:224
ds_read_b128 v[92:95], v4 offset:33504
s_waitcnt vmcnt(8)
s_waitcnt lgkmcnt(4)
v_mfma_f32_32x32x16_bf16 v[16:31], v[168:171], v[96:99], v[16:31]
buffer_load_dwordx4 v[208:211], v3, s[12:15], s33 offen offset:1024
v_mfma_f32_32x32x16_bf16 v[32:47], v[168:171], v[100:103], v[32:47]
v_mfma_f32_32x32x16_bf16 v[16:31], v[172:175], v[104:107], v[16:31]
buffer_load_dwordx4 v[212:215], v3, s[12:15], s37 offen offset:1024
v_mfma_f32_32x32x16_bf16 v[32:47], v[172:175], v[108:111], v[32:47]
ds_read_b128 v[96:99], v4 offset:704
ds_read_b128 v[100:103], v4 offset:33984
ds_read_b128 v[104:107], v4 offset:736
ds_read_b128 v[108:111], v4 offset:34016
s_waitcnt vmcnt(6)
s_waitcnt lgkmcnt(4)
v_mfma_f32_32x32x16_bf16 v[16:31], v[176:179], v[80:83], v[16:31]
buffer_load_dwordx4 v[216:219], v3, s[12:15], s41 offen offset:1024
v_mfma_f32_32x32x16_bf16 v[32:47], v[176:179], v[84:87], v[32:47]
v_mfma_f32_32x32x16_bf16 v[16:31], v[180:183], v[88:91], v[16:31]
buffer_load_dwordx4 v[220:223], v3, s[12:15], s45 offen offset:1024
v_mfma_f32_32x32x16_bf16 v[32:47], v[180:183], v[92:95], v[32:47]
ds_read_b128 v[80:83], v4 offset:256
ds_read_b128 v[84:87], v4 offset:33536
ds_read_b128 v[88:91], v4 offset:288
ds_read_b128 v[92:95], v4 offset:33568
s_waitcnt vmcnt(8)
s_waitcnt lgkmcnt(4)
v_mfma_f32_32x32x16_bf16 v[16:31], v[184:187], v[96:99], v[16:31]
buffer_load_dwordx4 v[224:227], v3, s[12:15], s33 offen offset:2048
v_mfma_f32_32x32x16_bf16 v[32:47], v[184:187], v[100:103], v[32:47]
v_mfma_f32_32x32x16_bf16 v[16:31], v[188:191], v[104:107], v[16:31]
buffer_load_dwordx4 v[228:231], v3, s[12:15], s37 offen offset:2048
v_mfma_f32_32x32x16_bf16 v[32:47], v[188:191], v[108:111], v[32:47]
ds_read_b128 v[96:99], v4 offset:768
ds_read_b128 v[100:103], v4 offset:34048
ds_read_b128 v[104:107], v4 offset:800
ds_read_b128 v[108:111], v4 offset:34080
s_waitcnt vmcnt(6)
s_waitcnt lgkmcnt(4)
v_mfma_f32_32x32x16_bf16 v[16:31], v[192:195], v[80:83], v[16:31]
buffer_load_dwordx4 v[232:235], v3, s[12:15], s41 offen offset:2048
v_mfma_f32_32x32x16_bf16 v[32:47], v[192:195], v[84:87], v[32:47]
v_mfma_f32_32x32x16_bf16 v[16:31], v[196:199], v[88:91], v[16:31]
buffer_load_dwordx4 v[236:239], v3, s[12:15], s45 offen offset:2048
v_mfma_f32_32x32x16_bf16 v[32:47], v[196:199], v[92:95], v[32:47]
ds_read_b128 v[80:83], v4 offset:320
ds_read_b128 v[84:87], v4 offset:33600
ds_read_b128 v[88:91], v4 offset:352
ds_read_b128 v[92:95], v4 offset:33632
s_waitcnt vmcnt(8)
s_waitcnt lgkmcnt(4)
v_mfma_f32_32x32x16_bf16 v[16:31], v[200:203], v[96:99], v[16:31]
buffer_load_dwordx4 v[240:243], v3, s[12:15], s33 offen offset:3072
v_mfma_f32_32x32x16_bf16 v[32:47], v[200:203], v[100:103], v[32:47]
v_mfma_f32_32x32x16_bf16 v[16:31], v[204:207], v[104:107], v[16:31]
buffer_load_dwordx4 v[244:247], v3, s[12:15], s37 offen offset:3072
v_mfma_f32_32x32x16_bf16 v[32:47], v[204:207], v[108:111], v[32:47]
ds_read_b128 v[96:99], v4 offset:832
ds_read_b128 v[100:103], v4 offset:34112
ds_read_b128 v[104:107], v4 offset:864
ds_read_b128 v[108:111], v4 offset:34144
ds_read_b64 v[112:113], v7 offset:0
ds_read_b64 v[114:115], v7 offset:512
ds_read_b64 v[116:117], v7 offset:1024
ds_read_b64 v[118:119], v7 offset:1536
ds_read_b64 v[120:121], v7 offset:2048
ds_read_b64 v[122:123], v7 offset:2560
ds_read_b64 v[124:125], v7 offset:3072
ds_read_b64 v[126:127], v7 offset:3584
s_waitcnt vmcnt(6)
s_waitcnt lgkmcnt(12)
v_mfma_f32_32x32x16_bf16 v[16:31], v[208:211], v[80:83], v[16:31]
buffer_load_dwordx4 v[248:251], v3, s[12:15], s41 offen offset:3072
v_mfma_f32_32x32x16_bf16 v[32:47], v[208:211], v[84:87], v[32:47]
v_mfma_f32_32x32x16_bf16 v[16:31], v[212:215], v[88:91], v[16:31]
buffer_load_dwordx4 v[252:255], v3, s[12:15], s45 offen offset:3072
v_mfma_f32_32x32x16_bf16 v[32:47], v[212:215], v[92:95], v[32:47]
ds_read_b128 v[80:83], v4 offset:384
ds_read_b128 v[84:87], v4 offset:33664
ds_read_b128 v[88:91], v4 offset:416
ds_read_b128 v[92:95], v4 offset:33696
s_waitcnt vmcnt(8)
s_waitcnt lgkmcnt(12)
v_mfma_f32_32x32x16_bf16 v[16:31], v[216:219], v[96:99], v[16:31]
v_mfma_f32_32x32x16_bf16 v[32:47], v[216:219], v[100:103], v[32:47]
v_mfma_f32_32x32x16_bf16 v[16:31], v[220:223], v[104:107], v[16:31]
v_mfma_f32_32x32x16_bf16 v[32:47], v[220:223], v[108:111], v[32:47]
ds_read_b128 v[96:99], v4 offset:896
ds_read_b128 v[100:103], v4 offset:34176
ds_read_b128 v[104:107], v4 offset:928
ds_read_b128 v[108:111], v4 offset:34208
s_waitcnt vmcnt(4)
s_waitcnt lgkmcnt(4)
v_mfma_f32_32x32x16_bf16 v[16:31], v[224:227], v[80:83], v[16:31]
v_pk_add_f32 v[112:113], v[112:113], v[114:115]
v_pk_add_f32 v[116:117], v[116:117], v[118:119]
v_pk_add_f32 v[120:121], v[120:121], v[122:123]
v_pk_add_f32 v[124:125], v[124:125], v[126:127]
v_pk_add_f32 v[112:113], v[112:113], v[116:117]
s_add_u32 s54, s53, 0
buffer_load_dwordx4 v[128:131], v11, s[12:15], s54 offen offset:0
v_mfma_f32_32x32x16_bf16 v[32:47], v[224:227], v[84:87], v[32:47]
v_pk_add_f32 v[120:121], v[120:121], v[124:125]
v_pk_add_f32 v[112:113], v[112:113], v[120:121]
v_mul_f32 v12, 0x3b000000, v112
v_mul_f32 v13, 0x3b000000, v113
v_fma_f32 v13, -v12, v12, v13
v_mfma_f32_32x32x16_bf16 v[16:31], v[228:231], v[88:91], v[16:31]
v_max_f32 v13, 0, v13
v_cvt_pk_bf16_f32 v14, v12, v13
v_lshlrev_b32 v12, 16, v14
v_and_b32 v13, 0xffff0000, v14
v_add_f32 v13, 0x3727c5ac, v13
buffer_load_dwordx4 v[132:135], v10, s[12:15], s54 offen offset:0
v_mfma_f32_32x32x16_bf16 v[32:47], v[228:231], v[92:95], v[32:47]
v_cvt_pk_bf16_f32 v13, v13, v13
v_lshlrev_b32 v13, 16, v13
v_sqrt_f32 v13, v13
s_nop 0
v_cvt_pk_bf16_f32 v13, v13, v13
v_lshlrev_b32 v13, 16, v13
ds_read_b128 v[80:83], v4 offset:448
ds_read_b128 v[84:87], v4 offset:33728
ds_read_b128 v[88:91], v4 offset:480
ds_read_b128 v[92:95], v4 offset:33760
s_waitcnt vmcnt(6)
s_waitcnt lgkmcnt(4)
v_mfma_f32_32x32x16_bf16 v[16:31], v[232:235], v[96:99], v[16:31]
v_rcp_f32 v13, v13
s_nop 0
v_mul_f32 v12, v12, v13
v_sub_f32 v12, 0, v12
v_mov_b32 v15, v13
v_mov_b32 v14, v12
buffer_load_dwordx4 v[136:139], v11, s[12:15], s54 offen offset:2048
v_mfma_f32_32x32x16_bf16 v[32:47], v[232:235], v[100:103], v[32:47]
v_permlane32_swap_b32 v13, v15
v_permlane32_swap_b32 v12, v14
v_mfma_f32_32x32x16_bf16 v[16:31], v[236:239], v[104:107], v[16:31]
buffer_load_dwordx4 v[140:143], v10, s[12:15], s54 offen offset:2048
v_mfma_f32_32x32x16_bf16 v[32:47], v[236:239], v[108:111], v[32:47]
ds_read_b128 v[96:99], v4 offset:960
ds_read_b128 v[100:103], v4 offset:34240
ds_read_b128 v[104:107], v4 offset:992
ds_read_b128 v[108:111], v4 offset:34272
s_waitcnt vmcnt(4)
s_waitcnt lgkmcnt(4)
v_mfma_f32_32x32x16_bf16 v[16:31], v[240:243], v[80:83], v[16:31]
s_add_u32 s54, s53, 4096
buffer_load_dwordx4 v[144:147], v11, s[12:15], s54 offen offset:0
v_mfma_f32_32x32x16_bf16 v[32:47], v[240:243], v[84:87], v[32:47]
v_mfma_f32_32x32x16_bf16 v[16:31], v[244:247], v[88:91], v[16:31]
buffer_load_dwordx4 v[148:151], v10, s[12:15], s54 offen offset:0
v_mfma_f32_32x32x16_bf16 v[32:47], v[244:247], v[92:95], v[32:47]
s_waitcnt vmcnt(6)
s_waitcnt lgkmcnt(0)
v_mfma_f32_32x32x16_bf16 v[16:31], v[248:251], v[96:99], v[16:31]
buffer_load_dwordx4 v[152:155], v11, s[12:15], s54 offen offset:2048
v_mfma_f32_32x32x16_bf16 v[32:47], v[248:251], v[100:103], v[32:47]
v_mfma_f32_32x32x16_bf16 v[16:31], v[252:255], v[104:107], v[16:31]
buffer_load_dwordx4 v[156:159], v10, s[12:15], s54 offen offset:2048
v_mfma_f32_32x32x16_bf16 v[32:47], v[252:255], v[108:111], v[32:47]
s_lshl_b32 s27, s3, 11
v_add_u32 v6, s27, v3
ds_read_b128 v[80:83], v9 offset:0
ds_read_b128 v[84:87], v9 offset:32
ds_read_b128 v[88:91], v9 offset:64
ds_read_b128 v[92:95], v9 offset:96
ds_read_b128 v[96:99], v9 offset:128
ds_read_b128 v[100:103], v9 offset:160
ds_read_b128 v[104:107], v9 offset:192
ds_read_b128 v[108:111], v9 offset:224
s_waitcnt lgkmcnt(0)
v_fma_f32 v16, v16, v13, v88
v_fma_f32 v17, v17, v13, v89
v_fma_f32 v18, v18, v13, v90
v_fma_f32 v19, v19, v13, v91
v_fma_f32 v20, v20, v13, v92
v_fma_f32 v21, v21, v13, v93
v_fma_f32 v22, v22, v13, v94
v_fma_f32 v23, v23, v13, v95
v_fma_f32 v16, v80, v12, v16
v_fma_f32 v17, v81, v12, v17
v_fma_f32 v18, v82, v12, v18
v_fma_f32 v19, v83, v12, v19
v_fma_f32 v20, v84, v12, v20
v_fma_f32 v21, v85, v12, v21
v_fma_f32 v22, v86, v12, v22
v_fma_f32 v23, v87, v12, v23
v_fma_f32 v24, v24, v13, v104
v_fma_f32 v25, v25, v13, v105
v_fma_f32 v26, v26, v13, v106
v_fma_f32 v27, v27, v13, v107
v_fma_f32 v28, v28, v13, v108
v_fma_f32 v29, v29, v13, v109
v_fma_f32 v30, v30, v13, v110
v_fma_f32 v31, v31, v13, v111
v_fma_f32 v24, v96, v12, v24
v_fma_f32 v25, v97, v12, v25
v_fma_f32 v26, v98, v12, v26
v_fma_f32 v27, v99, v12, v27
v_fma_f32 v28, v100, v12, v28
v_fma_f32 v29, v101, v12, v29
v_fma_f32 v30, v102, v12, v30
v_fma_f32 v31, v103, v12, v31
v_mul_f32 v16, v16, v24
v_mul_f32 v17, v17, v25
v_mul_f32 v18, v18, v26
v_mul_f32 v19, v19, v27
v_mul_f32 v20, v20, v28
v_mul_f32 v21, v21, v29
v_mul_f32 v22, v22, v30
v_mul_f32 v23, v23, v31
v_cvt_pk_bf16_f32 v112, v16, v17
v_cvt_pk_bf16_f32 v113, v18, v19
v_cvt_pk_bf16_f32 v114, v20, v21
v_cvt_pk_bf16_f32 v115, v22, v23
buffer_store_dwordx4 v[112:115], v3, s[12:15], s48 offen offset:0 sc1
ds_write_b128 v6, v[112:115] offset:0
v_fma_f32 v32, v32, v15, v88
v_fma_f32 v33, v33, v15, v89
v_fma_f32 v34, v34, v15, v90
v_fma_f32 v35, v35, v15, v91
v_fma_f32 v36, v36, v15, v92
v_fma_f32 v37, v37, v15, v93
v_fma_f32 v38, v38, v15, v94
v_fma_f32 v39, v39, v15, v95
v_fma_f32 v32, v80, v14, v32
v_fma_f32 v33, v81, v14, v33
v_fma_f32 v34, v82, v14, v34
v_fma_f32 v35, v83, v14, v35
v_fma_f32 v36, v84, v14, v36
v_fma_f32 v37, v85, v14, v37
v_fma_f32 v38, v86, v14, v38
v_fma_f32 v39, v87, v14, v39
v_fma_f32 v40, v40, v15, v104
v_fma_f32 v41, v41, v15, v105
v_fma_f32 v42, v42, v15, v106
v_fma_f32 v43, v43, v15, v107
v_fma_f32 v44, v44, v15, v108
v_fma_f32 v45, v45, v15, v109
v_fma_f32 v46, v46, v15, v110
v_fma_f32 v47, v47, v15, v111
v_fma_f32 v40, v96, v14, v40
v_fma_f32 v41, v97, v14, v41
v_fma_f32 v42, v98, v14, v42
v_fma_f32 v43, v99, v14, v43
v_fma_f32 v44, v100, v14, v44
v_fma_f32 v45, v101, v14, v45
v_fma_f32 v46, v102, v14, v46
v_fma_f32 v47, v103, v14, v47
v_mul_f32 v32, v32, v40
v_mul_f32 v33, v33, v41
v_mul_f32 v34, v34, v42
v_mul_f32 v35, v35, v43
v_mul_f32 v36, v36, v44
v_mul_f32 v37, v37, v45
v_mul_f32 v38, v38, v46
v_mul_f32 v39, v39, v47
v_cvt_pk_bf16_f32 v116, v32, v33
v_cvt_pk_bf16_f32 v117, v34, v35
v_cvt_pk_bf16_f32 v118, v36, v37
v_cvt_pk_bf16_f32 v119, v38, v39
buffer_store_dwordx4 v[116:119], v3, s[12:15], s48 offen offset:1024 sc1
ds_write_b128 v6, v[116:119] offset:1024
s_and_b32 s27, s3, 3
s_cmp_eq_u32 s27, 3
s_cbranch_scc0 K3_SP1
s_add_u32 s54, s53, 8192
buffer_load_dwordx4 v[160:163], v11, s[12:15], s54 offen offset:0
buffer_load_dwordx4 v[164:167], v10, s[12:15], s54 offen offset:0
buffer_load_dwordx4 v[168:171], v11, s[12:15], s54 offen offset:2048
buffer_load_dwordx4 v[172:175], v10, s[12:15], s54 offen offset:2048
s_add_u32 s54, s53, 12288
buffer_load_dwordx4 v[176:179], v11, s[12:15], s54 offen offset:0
buffer_load_dwordx4 v[180:183], v10, s[12:15], s54 offen offset:0
buffer_load_dwordx4 v[184:187], v11, s[12:15], s54 offen offset:2048
buffer_load_dwordx4 v[188:191], v10, s[12:15], s54 offen offset:2048
s_add_u32 s54, s53, 16384
buffer_load_dwordx4 v[192:195], v11, s[12:15], s54 offen offset:0
buffer_load_dwordx4 v[196:199], v10, s[12:15], s54 offen offset:0
buffer_load_dwordx4 v[200:203], v11, s[12:15], s54 offen offset:2048
buffer_load_dwordx4 v[204:207], v10, s[12:15], s54 offen offset:2048
s_add_u32 s54, s53, 20480
buffer_load_dwordx4 v[208:211], v11, s[12:15], s54 offen offset:0
buffer_load_dwordx4 v[212:215], v10, s[12:15], s54 offen offset:0
K3_SP1:
s_lshr_b32 s24, s3, 2
v_and_b32 v7, 31, v2
s_lshl_b32 s25, s24, 5
v_add_u32 v7, s25, v7
v_mul_u32_u24 v8, 1040, v7
v_lshl_add_u32 v8, v5, 4, v8
s_and_b32 s25, s3, 3
s_lshl_b32 s25, s25, 5
s_lshl_b32 s27, s21, 7
s_add_u32 s25, s25, s27
s_add_u32 s27, s25, 65536
v_add_u32 v8, s27, v8
ds_read_b128 v[12:15], v8
v_lshlrev_b32 v7, 15, v7
v_lshl_add_u32 v7, v5, 4, v7
s_lshl_b32 s27, s20, 10
s_add_u32 s29, s25, s27
s_lshl_b32 s30, s25, 1
s_add_u32 s30, s30, 10240
v_lshlrev_b32 v6, 5, v5
s_lshl_b32 s25, s24, 10
v_add_u32 v8, s25, v3
v_xor_b32 v9, 0x400, v8
s_mov_b32 s8, s56
s_mov_b32 s9, s57
s_lshl_b32 s27, s21, 2
v_mov_b32 v0, s27
v_mov_b32 v1, 1
s_lshl_b32 s27, s3, 2
v_mov_b32 v4, s27
s_waitcnt vmcnt(0)
s_waitcnt lgkmcnt(0)
s_barrier
s_cmp_eq_u32 s3, s50
s_cbranch_scc0 K3_NF
s_mov_b64 exec, 1
buffer_store_dword v1, v0, s[12:15], s26 offen sc1
s_mov_b64 exec, -1
K3_NF:
s_and_b32 s27, s3, 3
s_cmp_eq_u32 s27, 3
s_cbranch_scc1 K3_SP2
s_add_u32 s54, s53, 8192
buffer_load_dwordx4 v[160:163], v11, s[12:15], s54 offen offset:0
buffer_load_dwordx4 v[164:167], v10, s[12:15], s54 offen offset:0
buffer_load_dwordx4 v[168:171], v11, s[12:15], s54 offen offset:2048
buffer_load_dwordx4 v[172:175], v10, s[12:15], s54 offen offset:2048
s_add_u32 s54, s53, 12288
buffer_load_dwordx4 v[176:179], v11, s[12:15], s54 offen offset:0
buffer_load_dwordx4 v[180:183], v10, s[12:15], s54 offen offset:0
buffer_load_dwordx4 v[184:187], v11, s[12:15], s54 offen offset:2048
buffer_load_dwordx4 v[188:191], v10, s[12:15], s54 offen offset:2048
s_add_u32 s54, s53, 16384
buffer_load_dwordx4 v[192:195], v11, s[12:15], s54 offen offset:0
buffer_load_dwordx4 v[196:199], v10, s[12:15], s54 offen offset:0
buffer_load_dwordx4 v[200:203], v11, s[12:15], s54 offen offset:2048
buffer_load_dwordx4 v[204:207], v10, s[12:15], s54 offen offset:2048
s_add_u32 s54, s53, 20480
buffer_load_dwordx4 v[208:211], v11, s[12:15], s54 offen offset:0
buffer_load_dwordx4 v[212:215], v10, s[12:15], s54 offen offset:0
K3_SP2:
s_cmp_eq_u32 s3, s21
s_cbranch_scc0 K3_NO1
ds_read_b128 v[80:83], v8 offset:0
ds_read_b128 v[84:87], v9 offset:0
ds_read_b128 v[88:91], v8 offset:2048
ds_read_b128 v[92:95], v9 offset:2048
ds_read_b128 v[96:99], v8 offset:4096
ds_read_b128 v[100:103], v9 offset:4096
ds_read_b128 v[104:107], v8 offset:6144
ds_read_b128 v[108:111], v9 offset:6144
ds_read_b128 v[112:115], v8 offset:8192
ds_read_b128 v[116:119], v9 offset:8192
ds_read_b128 v[120:123], v8 offset:10240
ds_read_b128 v[124:127], v9 offset:10240
ds_read_b128 v[216:219], v8 offset:12288
ds_read_b128 v[220:223], v9 offset:12288
ds_read_b128 v[224:227], v8 offset:14336
ds_read_b128 v[228:231], v9 offset:14336
ds_read_b128 v[232:235], v8 offset:16384
ds_read_b128 v[236:239], v9 offset:16384
ds_read_b128 v[240:243], v8 offset:18432
ds_read_b128 v[244:247], v9 offset:18432
ds_read_b128 v[248:251], v8 offset:20480
ds_read_b128 v[252:255], v9 offset:20480
s_waitcnt lgkmcnt(0)
K3_NO1:
s_cmp_eq_u32 s3, s50
s_cbranch_scc0 K3_WAIT
v_lshlrev_b32 v4, 2, v2
s_mov_b64 exec, 0xff
s_mov_b32 s27, 0x100000
K3_POLL:
buffer_load_dword v1, v4, s[12:15], s26 offen sc1
s_sub_u32 s27, s27, 1
s_cmp_eq_u32 s27, 0
s_cbranch_scc1 K3_POLLED
s_waitcnt vmcnt(0)
v_cmp_ne_u32 vcc, 1, v1
s_cbranch_vccnz K3_POLL
K3_POLLED:
s_mov_b64 exec, -1
K3_WAIT:
s_barrier
s_cmp_eq_u32 s3, s21
s_cbranch_scc0 K3_NL1
s_waitcnt vmcnt(0)
v_mfma_f32_32x32x16_bf16 v[16:31], v[128:131], v[80:83], 0
v_mfma_f32_32x32x16_bf16 v[32:47], v[132:135], v[80:83], 0
v_mfma_f32_32x32x16_bf16 v[48:63], v[128:131], v[84:87], 0
v_mfma_f32_32x32x16_bf16 v[64:79], v[132:135], v[84:87], 0
v_mfma_f32_32x32x16_bf16 v[16:31], v[136:139], v[88:91], v[16:31]
v_mfma_f32_32x32x16_bf16 v[32:47], v[140:143], v[88:91], v[32:47]
v_mfma_f32_32x32x16_bf16 v[48:63], v[136:139], v[92:95], v[48:63]
v_mfma_f32_32x32x16_bf16 v[64:79], v[140:143], v[92:95], v[64:79]
v_mfma_f32_32x32x16_bf16 v[16:31], v[144:147], v[96:99], v[16:31]
v_mfma_f32_32x32x16_bf16 v[32:47], v[148:151], v[96:99], v[32:47]
v_mfma_f32_32x32x16_bf16 v[48:63], v[144:147], v[100:103], v[48:63]
v_mfma_f32_32x32x16_bf16 v[64:79], v[148:151], v[100:103], v[64:79]
v_mfma_f32_32x32x16_bf16 v[16:31], v[152:155], v[104:107], v[16:31]
v_mfma_f32_32x32x16_bf16 v[32:47], v[156:159], v[104:107], v[32:47]
v_mfma_f32_32x32x16_bf16 v[48:63], v[152:155], v[108:111], v[48:63]
v_mfma_f32_32x32x16_bf16 v[64:79], v[156:159], v[108:111], v[64:79]
v_mfma_f32_32x32x16_bf16 v[16:31], v[160:163], v[112:115], v[16:31]
v_mfma_f32_32x32x16_bf16 v[32:47], v[164:167], v[112:115], v[32:47]
v_mfma_f32_32x32x16_bf16 v[48:63], v[160:163], v[116:119], v[48:63]
v_mfma_f32_32x32x16_bf16 v[64:79], v[164:167], v[116:119], v[64:79]
v_mfma_f32_32x32x16_bf16 v[16:31], v[168:171], v[120:123], v[16:31]
v_mfma_f32_32x32x16_bf16 v[32:47], v[172:175], v[120:123], v[32:47]
v_mfma_f32_32x32x16_bf16 v[48:63], v[168:171], v[124:127], v[48:63]
v_mfma_f32_32x32x16_bf16 v[64:79], v[172:175], v[124:127], v[64:79]
v_mfma_f32_32x32x16_bf16 v[16:31], v[176:179], v[216:219], v[16:31]
v_mfma_f32_32x32x16_bf16 v[32:47], v[180:183], v[216:219], v[32:47]
v_mfma_f32_32x32x16_bf16 v[48:63], v[176:179], v[220:223], v[48:63]
v_mfma_f32_32x32x16_bf16 v[64:79], v[180:183], v[220:223], v[64:79]
v_mfma_f32_32x32x16_bf16 v[16:31], v[184:187], v[224:227], v[16:31]
v_mfma_f32_32x32x16_bf16 v[32:47], v[188:191], v[224:227], v[32:47]
v_mfma_f32_32x32x16_bf16 v[48:63], v[184:187], v[228:231], v[48:63]
v_mfma_f32_32x32x16_bf16 v[64:79], v[188:191], v[228:231], v[64:79]
v_mfma_f32_32x32x16_bf16 v[16:31], v[192:195], v[232:235], v[16:31]
v_mfma_f32_32x32x16_bf16 v[32:47], v[196:199], v[232:235], v[32:47]
v_mfma_f32_32x32x16_bf16 v[48:63], v[192:195], v[236:239], v[48:63]
v_mfma_f32_32x32x16_bf16 v[64:79], v[196:199], v[236:239], v[64:79]
v_mfma_f32_32x32x16_bf16 v[16:31], v[200:203], v[240:243], v[16:31]
v_mfma_f32_32x32x16_bf16 v[32:47], v[204:207], v[240:243], v[32:47]
v_mfma_f32_32x32x16_bf16 v[48:63], v[200:203], v[244:247], v[48:63]
v_mfma_f32_32x32x16_bf16 v[64:79], v[204:207], v[244:247], v[64:79]
v_mfma_f32_32x32x16_bf16 v[16:31], v[208:211], v[248:251], v[16:31]
v_mfma_f32_32x32x16_bf16 v[32:47], v[212:215], v[248:251], v[32:47]
v_mfma_f32_32x32x16_bf16 v[48:63], v[208:211], v[252:255], v[48:63]
v_mfma_f32_32x32x16_bf16 v[64:79], v[212:215], v[252:255], v[64:79]
buffer_load_dwordx4 v[80:83], v6, s[12:15], s30 offen
buffer_load_dwordx4 v[84:87], v6, s[12:15], s30 offen offset:16
s_nop 9
s_branch K3_RED
K3_NL1:
s_add_u32 s55, s52, 0
buffer_load_dwordx4 v[80:83], v8, s[12:15], s55 offen offset:0 sc1
buffer_load_dwordx4 v[84:87], v9, s[12:15], s55 offen offset:0 sc1
buffer_load_dwordx4 v[88:91], v8, s[12:15], s55 offen offset:2048 sc1
buffer_load_dwordx4 v[92:95], v9, s[12:15], s55 offen offset:2048 sc1
s_add_u32 s55, s52, 4096
buffer_load_dwordx4 v[96:99], v8, s[12:15], s55 offen offset:0 sc1
buffer_load_dwordx4 v[100:103], v9, s[12:15], s55 offen offset:0 sc1
buffer_load_dwordx4 v[104:107], v8, s[12:15], s55 offen offset:2048 sc1
buffer_load_dwordx4 v[108:111], v9, s[12:15], s55 offen offset:2048 sc1
s_waitcnt vmcnt(6)
v_mfma_f32_32x32x16_bf16 v[16:31], v[128:131], v[80:83], 0
v_mfma_f32_32x32x16_bf16 v[32:47], v[132:135], v[80:83], 0
v_mfma_f32_32x32x16_bf16 v[48:63], v[128:131], v[84:87], 0
v_mfma_f32_32x32x16_bf16 v[64:79], v[132:135], v[84:87], 0
s_add_u32 s55, s52, 8192
buffer_load_dwordx4 v[112:115], v8, s[12:15], s55 offen offset:0 sc1
buffer_load_dwordx4 v[116:119], v9, s[12:15], s55 offen offset:0 sc1
s_waitcnt vmcnt(6)
v_mfma_f32_32x32x16_bf16 v[16:31], v[136:139], v[88:91], v[16:31]
v_mfma_f32_32x32x16_bf16 v[32:47], v[140:143], v[88:91], v[32:47]
v_mfma_f32_32x32x16_bf16 v[48:63], v[136:139], v[92:95], v[48:63]
v_mfma_f32_32x32x16_bf16 v[64:79], v[140:143], v[92:95], v[64:79]
buffer_load_dwordx4 v[120:123], v8, s[12:15], s55 offen offset:2048 sc1
buffer_load_dwordx4 v[124:127], v9, s[12:15], s55 offen offset:2048 sc1
s_waitcnt vmcnt(6)
v_mfma_f32_32x32x16_bf16 v[16:31], v[144:147], v[96:99], v[16:31]
v_mfma_f32_32x32x16_bf16 v[32:47], v[148:151], v[96:99], v[32:47]
v_mfma_f32_32x32x16_bf16 v[48:63], v[144:147], v[100:103], v[48:63]
v_mfma_f32_32x32x16_bf16 v[64:79], v[148:151], v[100:103], v[64:79]
s_add_u32 s55, s52, 12288
buffer_load_dwordx4 v[216:219], v8, s[12:15], s55 offen offset:0 sc1
buffer_load_dwordx4 v[220:223], v9, s[12:15], s55 offen offset:0 sc1
s_waitcnt vmcnt(6)
v_mfma_f32_32x32x16_bf16 v[16:31], v[152:155], v[104:107], v[16:31]
v_mfma_f32_32x32x16_bf16 v[32:47], v[156:159], v[104:107], v[32:47]
v_mfma_f32_32x32x16_bf16 v[48:63], v[152:155], v[108:111], v[48:63]
v_mfma_f32_32x32x16_bf16 v[64:79], v[156:159], v[108:111], v[64:79]
buffer_load_dwordx4 v[224:227], v8, s[12:15], s55 offen offset:2048 sc1
buffer_load_dwordx4 v[228:231], v9, s[12:15], s55 offen offset:2048 sc1
s_waitcnt vmcnt(6)
v_mfma_f32_32x32x16_bf16 v[16:31], v[160:163], v[112:115], v[16:31]
v_mfma_f32_32x32x16_bf16 v[32:47], v[164:167], v[112:115], v[32:47]
v_mfma_f32_32x32x16_bf16 v[48:63], v[160:163], v[116:119], v[48:63]
v_mfma_f32_32x32x16_bf16 v[64:79], v[164:167], v[116:119], v[64:79]
s_add_u32 s55, s52, 16384
buffer_load_dwordx4 v[232:235], v8, s[12:15], s55 offen offset:0 sc1
buffer_load_dwordx4 v[236:239], v9, s[12:15], s55 offen offset:0 sc1
s_waitcnt vmcnt(6)
v_mfma_f32_32x32x16_bf16 v[16:31], v[168:171], v[120:123], v[16:31]
v_mfma_f32_32x32x16_bf16 v[32:47], v[172:175], v[120:123], v[32:47]
v_mfma_f32_32x32x16_bf16 v[48:63], v[168:171], v[124:127], v[48:63]
v_mfma_f32_32x32x16_bf16 v[64:79], v[172:175], v[124:127], v[64:79]
buffer_load_dwordx4 v[240:243], v8, s[12:15], s55 offen offset:2048 sc1
buffer_load_dwordx4 v[244:247], v9, s[12:15], s55 offen offset:2048 sc1
s_waitcnt vmcnt(6)
v_mfma_f32_32x32x16_bf16 v[16:31], v[176:179], v[216:219], v[16:31]
v_mfma_f32_32x32x16_bf16 v[32:47], v[180:183], v[216:219], v[32:47]
v_mfma_f32_32x32x16_bf16 v[48:63], v[176:179], v[220:223], v[48:63]
v_mfma_f32_32x32x16_bf16 v[64:79], v[180:183], v[220:223], v[64:79]
s_add_u32 s55, s52, 20480
buffer_load_dwordx4 v[248:251], v8, s[12:15], s55 offen offset:0 sc1
buffer_load_dwordx4 v[252:255], v9, s[12:15], s55 offen offset:0 sc1
s_waitcnt vmcnt(6)
v_mfma_f32_32x32x16_bf16 v[16:31], v[184:187], v[224:227], v[16:31]
v_mfma_f32_32x32x16_bf16 v[32:47], v[188:191], v[224:227], v[32:47]
v_mfma_f32_32x32x16_bf16 v[48:63], v[184:187], v[228:231], v[48:63]
v_mfma_f32_32x32x16_bf16 v[64:79], v[188:191], v[228:231], v[64:79]
buffer_load_dwordx4 v[80:83], v6, s[12:15], s30 offen
buffer_load_dwordx4 v[84:87], v6, s[12:15], s30 offen offset:16
s_waitcnt vmcnt(6)
v_mfma_f32_32x32x16_bf16 v[16:31], v[192:195], v[232:235], v[16:31]
v_mfma_f32_32x32x16_bf16 v[32:47], v[196:199], v[232:235], v[32:47]
v_mfma_f32_32x32x16_bf16 v[48:63], v[192:195], v[236:239], v[48:63]
v_mfma_f32_32x32x16_bf16 v[64:79], v[196:199], v[236:239], v[64:79]
s_waitcnt vmcnt(4)
v_mfma_f32_32x32x16_bf16 v[16:31], v[200:203], v[240:243], v[16:31]
v_mfma_f32_32x32x16_bf16 v[32:47], v[204:207], v[240:243], v[32:47]
v_mfma_f32_32x32x16_bf16 v[48:63], v[200:203], v[244:247], v[48:63]
v_mfma_f32_32x32x16_bf16 v[64:79], v[204:207], v[244:247], v[64:79]
s_waitcnt vmcnt(2)
v_mfma_f32_32x32x16_bf16 v[16:31], v[208:211], v[248:251], v[16:31]
v_mfma_f32_32x32x16_bf16 v[32:47], v[212:215], v[248:251], v[32:47]
v_mfma_f32_32x32x16_bf16 v[48:63], v[208:211], v[252:255], v[48:63]
v_mfma_f32_32x32x16_bf16 v[64:79], v[212:215], v[252:255], v[64:79]
K3_RED:
s_xor_b32 s27, s3, 1
s_mul_i32 s27, s27, 7168
v_add_u32 v5, s27, v3
s_nop 5
v_cvt_pk_bf16_f32 v24, v24, v25
v_cvt_pk_bf16_f32 v25, v26, v27
v_cvt_pk_bf16_f32 v26, v28, v29
v_cvt_pk_bf16_f32 v27, v30, v31
ds_write_b128 v5, v[24:27] offset:0
s_xor_b32 s27, s3, 2
s_mul_i32 s27, s27, 7168
v_add_u32 v4, s27, v3
v_cvt_pk_bf16_f32 v32, v32, v33
v_cvt_pk_bf16_f32 v33, v34, v35
v_cvt_pk_bf16_f32 v34, v36, v37
v_cvt_pk_bf16_f32 v35, v38, v39
ds_write_b128 v4, v[32:35] offset:1024
s_xor_b32 s27, s3, 3
s_mul_i32 s27, s27, 7168
v_add_u32 v5, s27, v3
v_cvt_pk_bf16_f32 v40, v40, v41
v_cvt_pk_bf16_f32 v41, v42, v43
v_cvt_pk_bf16_f32 v42, v44, v45
v_cvt_pk_bf16_f32 v43, v46, v47
ds_write_b128 v5, v[40:43] offset:2048
s_xor_b32 s27, s3, 4
s_mul_i32 s27, s27, 7168
v_add_u32 v4, s27, v3
v_cvt_pk_bf16_f32 v48, v48, v49
v_cvt_pk_bf16_f32 v49, v50, v51
v_cvt_pk_bf16_f32 v50, v52, v53
v_cvt_pk_bf16_f32 v51, v54, v55
ds_write_b128 v4, v[48:51] offset:3072
s_xor_b32 s27, s3, 5
s_mul_i32 s27, s27, 7168
v_add_u32 v5, s27, v3
v_cvt_pk_bf16_f32 v56, v56, v57
v_cvt_pk_bf16_f32 v57, v58, v59
v_cvt_pk_bf16_f32 v58, v60, v61
v_cvt_pk_bf16_f32 v59, v62, v63
ds_write_b128 v5, v[56:59] offset:4096
s_xor_b32 s27, s3, 6
s_mul_i32 s27, s27, 7168
v_add_u32 v4, s27, v3
v_cvt_pk_bf16_f32 v64, v64, v65
v_cvt_pk_bf16_f32 v65, v66, v67
v_cvt_pk_bf16_f32 v66, v68, v69
v_cvt_pk_bf16_f32 v67, v70, v71
ds_write_b128 v4, v[64:67] offset:5120
s_xor_b32 s27, s3, 7
s_mul_i32 s27, s27, 7168
v_add_u32 v5, s27, v3
v_cvt_pk_bf16_f32 v72, v72, v73
v_cvt_pk_bf16_f32 v73, v74, v75
v_cvt_pk_bf16_f32 v74, v76, v77
v_cvt_pk_bf16_f32 v75, v78, v79
ds_write_b128 v5, v[72:75] offset:6144
v_lshlrev_b32 v88, 16, v12
v_and_b32 v89, 0xffff0000, v12
v_lshlrev_b32 v90, 16, v13
v_and_b32 v91, 0xffff0000, v13
v_lshlrev_b32 v92, 16, v14
v_and_b32 v93, 0xffff0000, v14
v_lshlrev_b32 v94, 16, v15
v_and_b32 v95, 0xffff0000, v15
s_mul_i32 s27, s3, 7168
v_add_u32 v6, s27, v3
v_mov_b32 v4, 0x3f80
v_mov_b32 v5, 0x3f800000
s_waitcnt lgkmcnt(0)
s_barrier
ds_read_b128 v[128:131], v6 offset:0
ds_read_b128 v[132:135], v6 offset:1024
ds_read_b128 v[136:139], v6 offset:2048
ds_read_b128 v[140:143], v6 offset:3072
ds_read_b128 v[144:147], v6 offset:4096
ds_read_b128 v[148:151], v6 offset:5120
ds_read_b128 v[152:155], v6 offset:6144
s_waitcnt lgkmcnt(6)
v_dot2c_f32_bf16 v16, v128, v4
v_dot2c_f32_bf16 v17, v128, v5
v_dot2c_f32_bf16 v18, v129, v4
v_dot2c_f32_bf16 v19, v129, v5
v_dot2c_f32_bf16 v20, v130, v4
v_dot2c_f32_bf16 v21, v130, v5
v_dot2c_f32_bf16 v22, v131, v4
v_dot2c_f32_bf16 v23, v131, v5
s_waitcnt lgkmcnt(5)
v_dot2c_f32_bf16 v16, v132, v4
v_dot2c_f32_bf16 v17, v132, v5
v_dot2c_f32_bf16 v18, v133, v4
v_dot2c_f32_bf16 v19, v133, v5
v_dot2c_f32_bf16 v20, v134, v4
v_dot2c_f32_bf16 v21, v134, v5
v_dot2c_f32_bf16 v22, v135, v4
v_dot2c_f32_bf16 v23, v135, v5
s_waitcnt lgkmcnt(4)
v_dot2c_f32_bf16 v16, v136, v4
v_dot2c_f32_bf16 v17, v136, v5
v_dot2c_f32_bf16 v18, v137, v4
v_dot2c_f32_bf16 v19, v137, v5
v_dot2c_f32_bf16 v20, v138, v4
v_dot2c_f32_bf16 v21, v138, v5
v_dot2c_f32_bf16 v22, v139, v4
v_dot2c_f32_bf16 v23, v139, v5
s_waitcnt lgkmcnt(3)
v_dot2c_f32_bf16 v16, v140, v4
v_dot2c_f32_bf16 v17, v140, v5
v_dot2c_f32_bf16 v18, v141, v4
v_dot2c_f32_bf16 v19, v141, v5
v_dot2c_f32_bf16 v20, v142, v4
v_dot2c_f32_bf16 v21, v142, v5
v_dot2c_f32_bf16 v22, v143, v4
v_dot2c_f32_bf16 v23, v143, v5
s_waitcnt lgkmcnt(2)
v_dot2c_f32_bf16 v16, v144, v4
v_dot2c_f32_bf16 v17, v144, v5
v_dot2c_f32_bf16 v18, v145, v4
v_dot2c_f32_bf16 v19, v145, v5
v_dot2c_f32_bf16 v20, v146, v4
v_dot2c_f32_bf16 v21, v146, v5
v_dot2c_f32_bf16 v22, v147, v4
v_dot2c_f32_bf16 v23, v147, v5
s_waitcnt lgkmcnt(1)
v_dot2c_f32_bf16 v16, v148, v4
v_dot2c_f32_bf16 v17, v148, v5
v_dot2c_f32_bf16 v18, v149, v4
v_dot2c_f32_bf16 v19, v149, v5
v_dot2c_f32_bf16 v20, v150, v4
v_dot2c_f32_bf16 v21, v150, v5
v_dot2c_f32_bf16 v22, v151, v4
v_dot2c_f32_bf16 v23, v151, v5
s_waitcnt lgkmcnt(0)
v_dot2c_f32_bf16 v16, v152, v4
v_dot2c_f32_bf16 v17, v152, v5
v_dot2c_f32_bf16 v18, v153, v4
v_dot2c_f32_bf16 v19, v153, v5
v_dot2c_f32_bf16 v20, v154, v4
v_dot2c_f32_bf16 v21, v154, v5
v_dot2c_f32_bf16 v22, v155, v4
v_dot2c_f32_bf16 v23, v155, v5
s_waitcnt vmcnt(0)
v_fma_f32 v16, v16, v80, v88
v_fma_f32 v17, v17, v81, v89
v_fma_f32 v18, v18, v82, v90
v_fma_f32 v19, v19, v83, v91
v_fma_f32 v20, v20, v84, v92
v_fma_f32 v21, v21, v85, v93
v_fma_f32 v22, v22, v86, v94
v_fma_f32 v23, v23, v87, v95
v_cvt_pk_bf16_f32 v12, v16, v17
v_cvt_pk_bf16_f32 v13, v18, v19
v_cvt_pk_bf16_f32 v14, v20, v21
v_cvt_pk_bf16_f32 v15, v22, v23
buffer_store_dwordx4 v[12:15], v7, s[8:11], s29 offen
K3_END:
s_endpgm
CODE_END:
.section .rodata,"a"
.p2align 6
.amdhsa_kernel k12_kernel
  .amdhsa_next_free_vgpr 128
  .amdhsa_next_free_sgpr 102
  .amdhsa_accum_offset 128
  .amdhsa_group_segment_fixed_size 0
  .amdhsa_kernarg_size 96
  .amdhsa_user_sgpr_count 2
  .amdhsa_user_sgpr_kernarg_segment_ptr 1
  .amdhsa_system_sgpr_workgroup_id_x 1
.end_amdhsa_kernel
.p2align 6
.amdhsa_kernel k34_kernel
  .amdhsa_next_free_vgpr 256
  .amdhsa_next_free_sgpr 102
  .amdhsa_accum_offset 256
  .amdhsa_group_segment_fixed_size 0
  .amdhsa_kernarg_size 96
  .amdhsa_user_sgpr_count 2
  .amdhsa_user_sgpr_kernarg_segment_ptr 1
  .amdhsa_system_sgpr_workgroup_id_x 1
.end_amdhsa_kernel
.p2align 8
TAB_F1:
.long 0x3f803f80,0x3f803f80,0x3f803f80,0x3f803f80,0xbf803f80,0xbf803f80,0xbf803f80,0xbf803f80,0x3f7f3f80,0x3f753f7b,0xbdc9248d,0xbe95be48,0xbdc98000,0xbe95be48,0xbf7fbf80,0xbf75bf7b
.long 0x3f7b3f80,0x3f553f6d,0xbf7bbf80,0xbf55bf6d,0xbe488000,0xbf0ebec4,0x3e48a50d,0x3f0e3ec4,0x3f753f80,0x3f223f55,0x3e95a554,0x3f463f0e,0xbe958000,0xbf46bf0e,0x3f753f80,0x3f223f55
.long 0x3f6d3f80,0x3ec43f35,0x3f6d3f80,0x3ec43f35,0xbec48000,0xbf6dbf35,0xbec4258d,0xbf6dbf35,0x3f623f80,0x3dc93f0e,0xbef125b0,0xbf7fbf55,0xbef18000,0xbf7fbf55,0xbf62bf80,0xbdc9bf0e
.long 0x3f553f80,0xbe483ec4,0xbf55bf80,0x3e48bec4,0xbf0e8000,0xbf7bbf6d,0x3f0ea5d4,0x3f7b3f6d,0x3f463f80,0xbef13e48,0x3f22a5f7,0x3f623f7b,0xbf228000,0xbf62bf7b,0x3f463f80,0xbef13e48
.long 0x3f803f80,0x3f803f80,0x3f803f80,0x3f803f80,0xbf803f80,0xbf803f80,0xbf803f80,0xbf803f80,0x3f623f6d,0x3f463f55,0xbef1bec4,0xbf22bf0e,0xbef1bec4,0xbf22bf0e,0xbf62bf6d,0xbf46bf55
.long 0x3f0e3f35,0x3e483ec4,0xbf0ebf35,0xbe48bec4,0xbf55bf35,0xbf7bbf6d,0x3f553f35,0x3f7b3f6d,0x3dc93ec4,0xbef1be48,0x3f7f3f6d,0x3f623f7b,0xbf7fbf6d,0xbf62bf7b,0x3dc93ec4,0xbef1be48
.long 0xbec4248d,0xbf6dbf35,0xbec425b0,0xbf6dbf35,0xbf6dbf80,0xbec4bf35,0xbf6dbf80,0xbec4bf35,0xbf46bec4,0xbf75bf7b,0xbf22bf6d,0x3e95be48,0xbf22bf6d,0x3e95be48,0x3f463ec4,0x3f753f7b
.long 0xbf7bbf35,0xbf0ebf6d,0x3f7b3f35,0x3f0e3f6d,0xbe48bf35,0x3f553ec4,0x3e483f35,0xbf55bec4,0xbf75bf6d,0x3dc9bf0e,0xbe953ec4,0xbf7fbf55,0x3e95bec4,0x3f7f3f55,0xbf75bf6d,0x3dc9bf0e
.long 0x3f803f80,0x3f803f80,0x3f803f80,0x3f803f80,0xbf803f80,0xbf803f80,0xbf803f80,0xbf803f80,0x3f223f35,0x3ef13f0e,0xbf46bf35,0xbf62bf55,0xbf46bf35,0xbf62bf55,0xbf22bf35,0xbef1bf0e
.long 0xbe48248d,0xbf0ebec4,0x3e48a554,0x3f0e3ec4,0xbf7bbf80,0xbf55bf6d,0x3f7b3f80,0x3f553f6d,0xbf62bf35,0xbf7fbf7b,0x3ef13f35,0xbdc93e48,0xbef1bf35,0x3dc9be48,0xbf62bf35,0xbf7fbf7b
.long 0xbf6dbf80,0xbec4bf35,0xbf6dbf80,0xbec4bf35,0x3ec4a50d,0x3f6d3f35,0x3ec4a5d4,0x3f6d3f35,0xbe95bf35,0x3f223e48,0x3f753f35,0x3f463f7b,0x3f753f35,0x3f463f7b,0x3e953f35,0xbf22be48
.long 0x3f0ea554,0x3f7b3f6d,0xbf0e261f,0xbf7bbf6d,0x3f553f80,0xbe483ec4,0xbf55bf80,0x3e48bec4,0x3f7f3f35,0x3e953f55,0xbdc9bf35,0x3f753f0e,0x3dc93f35,0xbf75bf0e,0x3f7f3f35,0x3e953f55
.long 0x3f803f80,0x3f803f80,0x3f803f80,0x3f803f80,0xbf803f80,0xbf803f80,0xbf803f80,0xbf803f80,0x3e953ec4,0x3dc93e48,0xbf75bf6d,0xbf7fbf7b,0xbf75bf6d,0xbf7fbf7b,0xbe95bec4,0xbdc9be48
.long 0xbf55bf35,0xbf7bbf6d,0x3f553f35,0x3f7b3f6d,0xbf0ebf35,0xbe48bec4,0x3f0e3f35,0x3e483ec4,0xbf46bf6d,0xbe95bf0e,0xbf22bec4,0xbf75bf55,0x3f223ec4,0x3f753f55,0xbf46bf6d,0xbe95bf0e
.long 0x3ec4a554,0x3f6d3f35,0x3ec4a5f7,0x3f6d3f35,0x3f6d3f80,0x3ec43f35,0x3f6d3f80,0x3ec43f35,0x3f7f3f6d,0x3ef13f55,0xbdc93ec4,0xbf62bf0e,0xbdc93ec4,0xbf62bf0e,0xbf7fbf6d,0xbef1bf55
.long 0x3e483f35,0xbf55bec4,0xbe48bf35,0x3f553ec4,0xbf7bbf35,0xbf0ebf6d,0x3f7b3f35,0x3f0e3f6d,0xbf62bec4,0xbf22bf7b,0x3ef13f6d,0xbf46be48,0xbef1bf6d,0x3f463e48,0xbf62bec4,0xbf22bf7b
.long 0x3f803f80,0x3f803f80,0x3f803f80,0x3f803f80,0xbf803f80,0xbf803f80,0xbf803f80,0xbf803f80,0xbf7fbf80,0xbf75bf7b,0x3dc9a554,0x3e953e48,0x3dc9a50d,0x3e953e48,0x3f7f3f80,0x3f753f7b
.long 0x3f7b3f80,0x3f553f6d,0xbf7bbf80,0xbf55bf6d,0xbe48258d,0xbf0ebec4,0x3e48a5d4,0x3f0e3ec4,0xbf75bf80,0xbf22bf55,0xbe95261f,0xbf46bf0e,0x3e95a5d4,0x3f463f0e,0xbf75bf80,0xbf22bf55
.long 0x3f6d3f80,0x3ec43f35,0x3f6d3f80,0x3ec43f35,0xbec4260d,0xbf6dbf35,0xbec42654,0xbf6dbf35,0xbf62bf80,0xbdc9bf0e,0x3ef1a742,0x3f7f3f55,0x3ef1a630,0x3f7f3f55,0x3f623f80,0x3dc93f0e
.long 0x3f553f80,0xbe483ec4,0xbf55bf80,0x3e48bec4,0xbf0e2654,0xbf7bbf6d,0x3f0ea69f,0x3f7b3f6d,0xbf46bf80,0x3ef1be48,0xbf22a60d,0xbf62bf7b,0x3f22a677,0x3f623f7b,0xbf46bf80,0x3ef1be48
.long 0x3f803f80,0x3f803f80,0x3f803f80,0x3f803f80,0xbf803f80,0xbf803f80,0xbf803f80,0xbf803f80,0xbf62bf6d,0xbf46bf55,0x3ef13ec4,0x3f223f0e,0x3ef13ec4,0x3f223f0e,0x3f623f6d,0x3f463f55
.long 0x3f0e3f35,0x3e483ec4,0xbf0ebf35,0xbe48bec4,0xbf55bf35,0xbf7bbf6d,0x3f553f35,0x3f7b3f6d,0xbdc9bec4,0x3ef13e48,0xbf7fbf6d,0xbf62bf7b,0x3f7f3f6d,0x3f623f7b,0xbdc9bec4,0x3ef13e48
.long 0xbec4261f,0xbf6dbf35,0xbec4a68d,0xbf6dbf35,0xbf6dbf80,0xbec4bf35,0xbf6dbf80,0xbec4bf35,0x3f463ec4,0x3f753f7b,0x3f223f6d,0xbe953e48,0x3f223f6d,0xbe953e48,0xbf46bec4,0xbf75bf7b
.long 0xbf7bbf35,0xbf0ebf6d,0x3f7b3f35,0x3f0e3f6d,0xbe48bf35,0x3f553ec4,0x3e483f35,0xbf55bec4,0x3f753f6d,0xbdc93f0e,0x3e95bec4,0x3f7f3f55,0xbe953ec4,0xbf7fbf55,0x3f753f6d,0xbdc93f0e
.long 0x3f803f80,0x3f803f80,0x3f803f80,0x3f803f80,0xbf803f80,0xbf803f80,0xbf803f80,0xbf803f80,0xbf22bf35,0xbef1bf0e,0x3f463f35,0x3f623f55,0x3f463f35,0x3f623f55,0x3f223f35,0x3ef13f0e
.long 0xbe4825b0,0xbf0ebec4,0x3e48a5f7,0x3f0e3ec4,0xbf7bbf80,0xbf55bf6d,0x3f7b3f80,0x3f553f6d,0x3f623f35,0x3f7f3f7b,0xbef1bf35,0x3dc9be48,0x3ef13f35,0xbdc93e48,0x3f623f35,0x3f7f3f7b
.long 0xbf6dbf80,0xbec4bf35,0xbf6dbf80,0xbec4bf35,0x3ec4a630,0x3f6d3f35,0x3ec4a677,0x3f6d3f35,0x3e953f35,0xbf22be48,0xbf75bf35,0xbf46bf7b,0xbf75bf35,0xbf46bf7b,0xbe95bf35,0x3f223e48
.long 0x3f0ea742,0x3f7b3f6d,0xbf0ea60d,0xbf7bbf6d,0x3f553f80,0xbe483ec4,0xbf55bf80,0x3e48bec4,0xbf7fbf35,0xbe95bf55,0x3dc93f35,0xbf75bf0e,0xbdc9bf35,0x3f753f0e,0xbf7fbf35,0xbe95bf55
.long 0x3f803f80,0x3f803f80,0x3f803f80,0x3f803f80,0xbf803f80,0xbf803f80,0xbf803f80,0xbf803f80,0xbe95bec4,0xbdc9be48,0x3f753f6d,0x3f7f3f7b,0x3f753f6d,0x3f7f3f7b,0x3e953ec4,0x3dc93e48
.long 0xbf55bf35,0xbf7bbf6d,0x3f553f35,0x3f7b3f6d,0xbf0ebf35,0xbe48bec4,0x3f0e3f35,0x3e483ec4,0x3f463f6d,0x3e953f0e,0x3f223ec4,0x3f753f55,0xbf22bec4,0xbf75bf55,0x3f463f6d,0x3e953f0e
.long 0x3ec4a731,0x3f6d3f35,0x3ec4a742,0x3f6d3f35,0x3f6d3f80,0x3ec43f35,0x3f6d3f80,0x3ec43f35,0xbf7fbf6d,0xbef1bf55,0x3dc9bec4,0x3f623f0e,0x3dc9bec4,0x3f623f0e,0x3f7f3f6d,0x3ef13f55
.long 0x3e483f35,0xbf55bec4,0xbe48bf35,0x3f553ec4,0xbf7bbf35,0xbf0ebf6d,0x3f7b3f35,0x3f0e3f6d,0x3f623ec4,0x3f223f7b,0xbef1bf6d,0x3f463e48,0x3ef13f6d,0xbf46be48,0x3f623ec4,0x3f223f7b
.long 0x3f353f80,0xbf35248d,0x3f353f80,0xbf35261f,0xbf358000,0xbf35bf80,0xbf35260d,0xbf35bf80,0x3f223f80,0xbf62be48,0xbf46261f,0xbef1bf7b,0xbf468000,0xbef1bf7b,0xbf22bf80,0x3f623e48
.long 0x3f0e3f80,0xbf7bbec4,0xbf0ebf80,0x3f7b3ec4,0xbf558000,0xbe48bf6d,0x3f55a630,0x3e483f6d,0x3ef13f80,0xbf7fbf0e,0x3f62a731,0xbdc93f55,0xbf628000,0x3dc9bf55,0x3ef13f80,0xbf7fbf0e
.long 0x3ec43f80,0xbf6dbf35,0x3ec43f80,0xbf6dbf35,0xbf6d8000,0x3ec4bf35,0xbf6d2654,0x3ec4bf35,0x3e953f80,0xbf46bf55,0xbf75a68d,0x3f22bf0e,0xbf758000,0x3f22bf0e,0xbe95bf80,0x3f463f55
.long 0x3e483f80,0xbf0ebf6d,0xbe48bf80,0x3f0e3f6d,0xbf7b8000,0x3f55bec4,0x3f7ba677,0xbf553ec4,0x3dc93f80,0xbe95bf7b,0x3f7fa742,0xbf753e48,0xbf7f8000,0x3f75be48,0x3dc93f80,0xbe95bf7b
.long 0xbf35bf80,0x3f35a554,0xbf35bf80,0x3f35a731,0x3f35a50d,0x3f353f80,0x3f35a630,0x3f353f80,0xbe95bf6d,0x3f7f3f0e,0x3f753ec4,0x3dc93f55,0x3f753ec4,0x3dc93f55,0x3e953f6d,0xbf7fbf0e
.long 0x3e48bf35,0x3f553f6d,0xbe483f35,0xbf55bf6d,0x3f7b3f35,0xbf0e3ec4,0xbf7bbf35,0x3f0ebec4,0x3f22bec4,0x3e953f7b,0xbf46bf6d,0x3f753e48,0x3f463f6d,0xbf75be48,0x3f22bec4,0x3e953f7b
.long 0x3f6da554,0xbec43f35,0x3f6da742,0xbec43f35,0x3ec43f80,0xbf6dbf35,0x3ec43f80,0xbf6dbf35,0x3f7f3ec4,0xbf623e48,0xbdc93f6d,0xbef1bf7b,0xbdc93f6d,0xbef1bf7b,0xbf7fbec4,0x3f62be48
.long 0x3f553f35,0xbf7bbec4,0xbf55bf35,0x3f7b3ec4,0xbf0e3f35,0x3e48bf6d,0x3f0ebf35,0xbe483f6d,0x3ef13f6d,0xbf22bf55,0x3f62bec4,0xbf463f0e,0xbf623ec4,0x3f46bf0e,0x3ef13f6d,0xbf22bf55
.long 0x3f353f80,0xbf3525b0,0x3f353f80,0xbf35a68d,0xbf35258d,0xbf35bf80,0xbf352654,0xbf35bf80,0xbdc93f35,0xbf75bf55,0xbf7fbf35,0x3e95bf0e,0xbf7fbf35,0x3e95bf0e,0x3dc9bf35,0x3f753f55
.long 0xbf5525b0,0xbe48bf6d,0x3f55a742,0x3e483f6d,0xbf0ebf80,0x3f7b3ec4,0x3f0e3f80,0xbf7bbec4,0xbf75bf35,0x3f46be48,0xbe953f35,0xbf22bf7b,0x3e95bf35,0x3f223f7b,0xbf75bf35,0x3f46be48
.long 0xbec4bf80,0x3f6d3f35,0xbec4bf80,0x3f6d3f35,0x3f6da5d4,0xbec43f35,0x3f6da69f,0xbec43f35,0x3ef1bf35,0x3dc93f7b,0x3f623f35,0xbf7fbe48,0x3f623f35,0xbf7fbe48,0xbef13f35,0xbdc9bf7b
.long 0x3f7ba5f7,0xbf553ec4,0xbf7ba60d,0x3f55bec4,0x3e483f80,0xbf0ebf6d,0xbe48bf80,0x3f0e3f6d,0x3f463f35,0xbf62bf0e,0x3f22bf35,0xbef13f55,0xbf223f35,0x3ef1bf55,0x3f463f35,0xbf62bf0e
.long 0xbf35bf80,0x3f35a5f7,0xbf35bf80,0x3f35a742,0x3f35a5d4,0x3f353f80,0x3f35a677,0x3f353f80,0x3ef1bec4,0x3f463f7b,0x3f623f6d,0xbf223e48,0x3f623f6d,0xbf223e48,0xbef13ec4,0xbf46bf7b
.long 0x3f7b3f35,0xbf0e3ec4,0xbf7bbf35,0x3f0ebec4,0xbe483f35,0xbf55bf6d,0x3e48bf35,0x3f553f6d,0x3dc93f6d,0xbf62bf55,0x3f7f3ec4,0xbef13f0e,0xbf7fbec4,0x3ef1bf0e,0x3dc93f6d,0xbf62bf55
.long 0xbf6d261f,0x3ec4bf35,0xbf6da60d,0x3ec4bf35,0xbec4bf80,0x3f6d3f35,0xbec4bf80,0x3f6d3f35,0xbf22bf6d,0x3f753f0e,0x3f46bec4,0xbe953f55,0x3f46bec4,0xbe953f55,0x3f223f6d,0xbf75bf0e
.long 0x3f0ebf35,0xbe483f6d,0xbf0e3f35,0x3e48bf6d,0x3f553f35,0xbf7bbec4,0xbf55bf35,0x3f7b3ec4,0x3f753ec4,0xbf7fbe48,0x3e95bf6d,0xbdc93f7b,0xbe953f6d,0x3dc9bf7b,0x3f753ec4,0xbf7fbe48
.long 0x3f353f80,0xbf35a654,0x3f353f80,0xbf35a58e,0xbf35268d,0xbf35bf80,0xbf3526d4,0xbf35bf80,0xbf22bf80,0x3f623e48,0x3f46a777,0x3ef13f7b,0x3f46a69f,0x3ef13f7b,0x3f223f80,0xbf62be48
.long 0x3f0e3f80,0xbf7bbec4,0xbf0ebf80,0x3f7b3ec4,0xbf5526b0,0xbe48bf6d,0x3f55a7c2,0x3e483f6d,0xbef1bf80,0x3f7f3f0e,0xbf62258d,0x3dc9bf55,0x3f62a7b1,0xbdc93f55,0xbef1bf80,0x3f7f3f0e
.long 0x3ec43f80,0xbf6dbf35,0x3ec43f80,0xbf6dbf35,0xbf6d26d4,0x3ec4bf35,0xbf6d271f,0x3ec4bf35,0xbe95bf80,0x3f463f55,0x3f75a796,0xbf223f0e,0x3f75270d,0xbf223f0e,0x3e953f80,0xbf46bf55
.long 0x3e483f80,0xbf0ebf6d,0xbe48bf80,0x3f0e3f6d,0xbf7b26f7,0x3f55bec4,0x3f7b268d,0xbf553ec4,0xbdc9bf80,0x3e953f7b,0xbf7f268d,0x3f75be48,0x3f7fa7c2,0xbf753e48,0xbdc9bf80,0x3e953f7b
.long 0xbf35bf80,0x3f35a754,0xbf35bf80,0x3f35a777,0x3f35a69f,0x3f353f80,0x3f35270d,0x3f353f80,0x3e953f6d,0xbf7fbf0e,0xbf75bec4,0xbdc9bf55,0xbf75bec4,0xbdc9bf55,0xbe95bf6d,0x3f7f3f0e
.long 0x3e48bf35,0x3f553f6d,0xbe483f35,0xbf55bf6d,0x3f7b3f35,0xbf0e3ec4,0xbf7bbf35,0x3f0ebec4,0xbf223ec4,0xbe95bf7b,0x3f463f6d,0xbf75be48,0xbf46bf6d,0x3f753e48,0xbf223ec4,0xbe95bf7b
.long 0x3f6da777,0xbec43f35,0x3f6d2754,0xbec43f35,0x3ec43f80,0xbf6dbf35,0x3ec43f80,0xbf6dbf35,0xbf7fbec4,0x3f62be48,0x3dc9bf6d,0x3ef13f7b,0x3dc9bf6d,0x3ef13f7b,0x3f7f3ec4,0xbf623e48
.long 0x3f553f35,0xbf7bbec4,0xbf55bf35,0x3f7b3ec4,0xbf0e3f35,0x3e48bf6d,0x3f0ebf35,0xbe483f6d,0xbef1bf6d,0x3f223f55,0xbf623ec4,0x3f46bf0e,0x3f62bec4,0xbf463f0e,0xbef1bf6d,0x3f223f55
.long 0x3f353f80,0xbf35a60d,0x3f353f80,0xbf35a137,0xbf3526b0,0xbf35bf80,0xbf3526f7,0xbf35bf80,0x3dc9bf35,0x3f753f55,0x3f7f3f35,0xbe953f0e,0x3f7f3f35,0xbe953f0e,0xbdc93f35,0xbf75bf55
.long 0xbf55a58e,0xbe48bf6d,0x3f55a78d,0x3e483f6d,0xbf0ebf80,0x3f7b3ec4,0x3f0e3f80,0xbf7bbec4,0x3f753f35,0xbf463e48,0x3e95bf35,0x3f223f7b,0xbe953f35,0xbf22bf7b,0x3f753f35,0xbf463e48
.long 0xbec4bf80,0x3f6d3f35,0xbec4bf80,0x3f6d3f35,0x3f6da7c2,0xbec43f35,0x3f6d268d,0xbec43f35,0xbef13f35,0xbdc9bf7b,0xbf62bf35,0x3f7f3e48,0xbf62bf35,0x3f7f3e48,0x3ef1bf35,0x3dc93f7b
.long 0x3f7ba78d,0xbf553ec4,0xbf7b2816,0x3f55bec4,0x3e483f80,0xbf0ebf6d,0xbe48bf80,0x3f0e3f6d,0xbf46bf35,0x3f623f0e,0xbf223f35,0x3ef1bf55,0x3f22bf35,0xbef13f55,0xbf46bf35,0x3f623f0e
.long 0xbf35bf80,0x3f35a765,0xbf35bf80,0x3f35a784,0x3f35a7b1,0x3f353f80,0x3f35a7c2,0x3f353f80,0xbef13ec4,0xbf46bf7b,0xbf62bf6d,0x3f22be48,0xbf62bf6d,0x3f22be48,0x3ef1bec4,0x3f463f7b
.long 0x3f7b3f35,0xbf0e3ec4,0xbf7bbf35,0x3f0ebec4,0xbe483f35,0xbf55bf6d,0x3e48bf35,0x3f553f6d,0xbdc9bf6d,0x3f623f55,0xbf7fbec4,0x3ef1bf0e,0x3f7f3ec4,0xbef13f0e,0xbdc9bf6d,0x3f623f55
.long 0xbf6d2804,0x3ec4bf35,0xbf6d2889,0x3ec4bf35,0xbec4bf80,0x3f6d3f35,0xbec4bf80,0x3f6d3f35,0x3f223f6d,0xbf75bf0e,0xbf463ec4,0x3e95bf55,0xbf463ec4,0x3e95bf55,0xbf22bf6d,0x3f753f0e
.long 0x3f0ebf35,0xbe483f6d,0xbf0e3f35,0x3e48bf6d,0x3f553f35,0xbf7bbec4,0xbf55bf35,0x3f7b3ec4,0xbf75bec4,0x3f7f3e48,0xbe953f6d,0x3dc9bf7b,0x3e95bf6d,0xbdc93f7b,0xbf75bec4,0x3f7f3e48
.long 0x248d3f80,0xa554bf80,0xa6543f80,0xa754bf80,0xbf808000,0x3f80a50d,0xbf80268d,0x3f80a69f,0xbdc93f80,0x3e95bf7b,0xbf7fa654,0x3f753e48,0xbf7f8000,0x3f753e48,0x3dc9bf80,0xbe953f7b
.long 0xbe483f80,0x3f0ebf6d,0x3e48bf80,0xbf0e3f6d,0xbf7b8000,0x3f553ec4,0x3f7ba69f,0xbf55bec4,0xbe953f80,0x3f46bf55,0x3f75a754,0xbf22bf0e,0xbf758000,0x3f223f0e,0xbe953f80,0x3f46bf55
.long 0xbec43f80,0x3f6dbf35,0xbec43f80,0x3f6dbf35,0xbf6d8000,0x3ec43f35,0xbf6d26b0,0x3ec43f35,0xbef13f80,0x3f7fbf0e,0xbf62a60d,0x3dc93f55,0xbf628000,0x3dc93f55,0x3ef1bf80,0xbf7f3f0e
.long 0xbf0e3f80,0x3f7bbec4,0x3f0ebf80,0xbf7b3ec4,0xbf558000,0xbe483f6d,0x3f55a7b1,0x3e48bf6d,0xbf223f80,0x3f62be48,0x3f46a765,0x3ef1bf7b,0xbf468000,0xbef13f7b,0xbf223f80,0x3f62be48
.long 0x25b03f80,0xa5f7bf80,0xa60d3f80,0xa765bf80,0xbf80258d,0x3f80a5d4,0xbf8026b0,0x3f80a7b1,0xbef13f6d,0x3f22bf55,0xbf62bec4,0x3f463f0e,0xbf62bec4,0x3f463f0e,0x3ef1bf6d,0xbf223f55
.long 0xbf553f35,0x3f7bbec4,0x3f55bf35,0xbf7b3ec4,0xbf0ebf35,0x3e483f6d,0x3f0e3f35,0xbe48bf6d,0xbf7f3ec4,0x3f623e48,0x3dc93f6d,0x3ef1bf7b,0xbdc9bf6d,0xbef13f7b,0xbf7f3ec4,0x3f623e48
.long 0xbf6d25b0,0x3ec43f35,0xbf6da58e,0x3ec43f35,0x3ec4bf80,0xbf6d3f35,0x3ec4bf80,0xbf6d3f35,0xbf22bec4,0xbe953f7b,0x3f46bf6d,0xbf753e48,0x3f46bf6d,0xbf753e48,0x3f223ec4,0x3e95bf7b
.long 0xbe48bf35,0xbf553f6d,0x3e483f35,0x3f55bf6d,0x3f7bbf35,0xbf0ebec4,0xbf7b3f35,0x3f0e3ec4,0x3e95bf6d,0xbf7f3f0e,0xbf753ec4,0xbdc93f55,0x3f75bec4,0x3dc9bf55,0x3e95bf6d,0xbf7f3f0e
.long 0x261f3f80,0xa731bf80,0xa58e3f80,0xa777bf80,0xbf80260d,0x3f80a630,0xbf8026d4,0x3f80270d,0xbf463f35,0x3f62bf0e,0xbf22bf35,0x3ef13f55,0xbf22bf35,0x3ef13f55,0x3f46bf35,0xbf623f0e
.long 0xbf7b261f,0x3f553ec4,0x3f7ba777,0xbf55bec4,0x3e48bf80,0xbf0e3f6d,0xbe483f80,0x3f0ebf6d,0xbef1bf35,0xbdc93f7b,0xbf623f35,0x3f7fbe48,0x3f62bf35,0xbf7f3e48,0xbef1bf35,0xbdc93f7b
.long 0x3ec4bf80,0xbf6d3f35,0x3ec4bf80,0xbf6d3f35,0x3f6da630,0xbec4bf35,0x3f6da7c2,0xbec4bf35,0x3f75bf35,0xbf46be48,0x3e953f35,0x3f22bf7b,0x3e953f35,0x3f22bf7b,0xbf753f35,0x3f463e48
.long 0x3f55a731,0x3e48bf6d,0xbf55258d,0xbe483f6d,0xbf0e3f80,0x3f7bbec4,0x3f0ebf80,0xbf7b3ec4,0x3dc93f35,0x3f75bf55,0x3f7fbf35,0xbe95bf0e,0xbf7f3f35,0x3e953f0e,0x3dc93f35,0x3f75bf55
.long 0xa68d3f80,0xa742bf80,0xa1373f80,0xa784bf80,0xbf802654,0x3f80a677,0xbf8026f7,0x3f80a7c2,0xbf753ec4,0x3f7fbe48,0xbe95bf6d,0x3dc93f7b,0xbe95bf6d,0x3dc93f7b,0x3f75bec4,0xbf7f3e48
.long 0xbf0ebf35,0x3e483f6d,0x3f0e3f35,0xbe48bf6d,0x3f55bf35,0xbf7b3ec4,0xbf553f35,0x3f7bbec4,0x3f22bf6d,0xbf753f0e,0xbf46bec4,0x3e953f55,0x3f463ec4,0xbe95bf55,0x3f22bf6d,0xbf753f0e
.long 0x3f6da742,0xbec4bf35,0x3f6da78d,0xbec4bf35,0xbec43f80,0x3f6dbf35,0xbec43f80,0x3f6dbf35,0xbdc93f6d,0x3f62bf55,0xbf7f3ec4,0x3ef13f0e,0xbf7f3ec4,0x3ef13f0e,0x3dc9bf6d,0xbf623f55
.long 0xbf7b3f35,0x3f0e3ec4,0x3f7bbf35,0xbf0ebec4,0xbe48bf35,0xbf553f6d,0x3e483f35,0x3f55bf6d,0xbef1bec4,0xbf463f7b,0xbf623f6d,0x3f223e48,0x3f62bf6d,0xbf22be48,0xbef1bec4,0xbf463f7b
.long 0x258d3f80,0xa78dbf80,0x28163f80,0xa7b1bf80,0xbf80270d,0x3f8026d4,0xbf802754,0x3f80260e,0x3dc9bf80,0xbe953f7b,0x3f7fa7b1,0xbf75be48,0x3f7f26d4,0xbf75be48,0xbdc93f80,0x3e95bf7b
.long 0xbe483f80,0x3f0ebf6d,0x3e48bf80,0xbf0e3f6d,0xbf7b271f,0x3f553ec4,0x3f7ba7f7,0xbf55bec4,0x3e95bf80,0xbf463f55,0xbf75281f,0x3f223f0e,0x3f75a7d4,0xbf22bf0e,0x3e95bf80,0xbf463f55
.long 0xbec43f80,0x3f6dbf35,0xbec43f80,0x3f6dbf35,0xbf6d2730,0x3ec43f35,0xbf6d2842,0x3ec43f35,0x3ef1bf80,0xbf7f3f0e,0x3f6226d4,0xbdc9bf55,0x3f62268d,0xbdc9bf55,0xbef13f80,0x3f7fbf0e
.long 0xbf0e3f80,0x3f7bbec4,0x3f0ebf80,0xbf7b3ec4,0xbf552831,0xbe483f6d,0x3f55a60d,0x3e48bf6d,0x3f22bf80,0xbf623e48,0xbf462730,0xbef13f7b,0x3f46a7e5,0x3ef1bf7b,0x3f22bf80,0xbf623e48
.long 0x260d3f80,0xa796bf80,0x26d43f80,0x270dbf80,0xbf80271f,0x3f80a7d4,0xbf80a78d,0x3f80a7f7,0x3ef1bf6d,0xbf223f55,0x3f623ec4,0xbf46bf0e,0x3f623ec4,0xbf46bf0e,0xbef13f6d,0x3f22bf55
.long 0xbf553f35,0x3f7bbec4,0x3f55bf35,0xbf7b3ec4,0xbf0ebf35,0x3e483f6d,0x3f0e3f35,0xbe48bf6d,0x3f7fbec4,0xbf62be48,0xbdc9bf6d,0xbef13f7b,0x3dc93f6d,0x3ef1bf7b,0x3f7fbec4,0xbf62be48
.long 0xbf6d268d,0x3ec43f35,0xbf6da7b1,0x3ec43f35,0x3ec4bf80,0xbf6d3f35,0x3ec4bf80,0xbf6d3f35,0x3f223ec4,0x3e95bf7b,0xbf463f6d,0x3f75be48,0xbf463f6d,0x3f75be48,0xbf22bec4,0xbe953f7b
.long 0xbe48bf35,0xbf553f6d,0x3e483f35,0x3f55bf6d,0x3f7bbf35,0xbf0ebec4,0xbf7b3f35,0x3f0e3ec4,0xbe953f6d,0x3f7fbf0e,0x3f75bec4,0x3dc9bf55,0xbf753ec4,0xbdc93f55,0xbe953f6d,0x3f7fbf0e
.long 0x280d3f80,0xa79fbf80,0x281f3f80,0xa7c2bf80,0xbf802730,0x3f80268d,0xbf802777,0x3f8021b7,0x3f46bf35,0xbf623f0e,0x3f223f35,0xbef1bf55,0x3f223f35,0xbef1bf55,0xbf463f35,0x3f62bf0e
.long 0xbf7b268d,0x3f553ec4,0x3f7b26d4,0xbf55bec4,0x3e48bf80,0xbf0e3f6d,0xbe483f80,0x3f0ebf6d,0x3ef13f35,0x3dc9bf7b,0x3f62bf35,0xbf7f3e48,0xbf623f35,0x3f7fbe48,0x3ef13f35,0x3dc9bf7b
.long 0x3ec4bf80,0xbf6d3f35,0x3ec4bf80,0xbf6d3f35,0x3f6d260e,0xbec4bf35,0x3f6da80d,0xbec4bf35,0xbf753f35,0x3f463e48,0xbe95bf35,0xbf223f7b,0xbe95bf35,0xbf223f7b,0x3f75bf35,0xbf46be48
.long 0x3f55270d,0x3e48bf6d,0xbf552754,0xbe483f6d,0xbf0e3f80,0x3f7bbec4,0x3f0ebf80,0xbf7b3ec4,0xbdc9bf35,0xbf753f55,0xbf7f3f35,0x3e953f0e,0x3f7fbf35,0xbe95bf0e,0xbdc9bf35,0xbf753f55
.long 0x268d3f80,0x2731bf80,0x270d3f80,0x26d4bf80,0xbf802831,0x3f80a7e5,0xbf802842,0x3f80a804,0x3f75bec4,0xbf7f3e48,0x3e953f6d,0xbdc9bf7b,0x3e953f6d,0xbdc9bf7b,0xbf753ec4,0x3f7fbe48
.long 0xbf0ebf35,0x3e483f6d,0x3f0e3f35,0xbe48bf6d,0x3f55bf35,0xbf7b3ec4,0xbf553f35,0x3f7bbec4,0xbf223f6d,0x3f75bf0e,0x3f463ec4,0xbe95bf55,0xbf46bec4,0x3e953f55,0xbf223f6d,0x3f75bf0e
.long 0x3f6da85d,0xbec4bf35,0x3f6da7e5,0xbec4bf35,0xbec43f80,0x3f6dbf35,0xbec43f80,0x3f6dbf35,0x3dc9bf6d,0xbf623f55,0x3f7fbec4,0xbef1bf0e,0x3f7fbec4,0xbef1bf0e,0xbdc93f6d,0x3f62bf55
.long 0xbf7b3f35,0x3f0e3ec4,0x3f7bbf35,0xbf0ebec4,0xbe48bf35,0xbf553f6d,0x3e483f35,0x3f55bf6d,0x3ef13ec4,0x3f46bf7b,0x3f62bf6d,0xbf22be48,0xbf623f6d,0x3f223e48,0x3ef13ec4,0x3f46bf7b
.long 0xbf353f80,0x3f35a554,0xbf353f80,0x3f35a777,0xbf358000,0xbf353f80,0xbf3526d4,0xbf353f80,0xbf463f80,0x3ef13e48,0xbf22a58e,0xbf623f7b,0xbf228000,0xbf623f7b,0x3f46bf80,0xbef1be48
.long 0xbf553f80,0x3e483ec4,0x3f55bf80,0xbe48bec4,0xbf0e8000,0xbf7b3f6d,0x3f0e270d,0x3f7bbf6d,0xbf623f80,0xbdc93f0e,0x3ef1a777,0x3f7fbf55,0xbef18000,0xbf7f3f55,0xbf623f80,0xbdc93f0e
.long 0xbf6d3f80,0xbec43f35,0xbf6d3f80,0xbec43f35,0xbec48000,0xbf6d3f35,0xbec426f7,0xbf6d3f35,0xbf753f80,0xbf223f55,0xbe95a137,0xbf463f0e,0xbe958000,0xbf463f0e,0x3f75bf80,0x3f22bf55
.long 0xbf7b3f80,0xbf553f6d,0x3f7bbf80,0x3f55bf6d,0xbe488000,0xbf0e3ec4,0x3e48a7c2,0x3f0ebec4,0xbf7f3f80,0xbf753f7b,0x3dc9a784,0x3e95be48,0xbdc98000,0xbe953e48,0xbf7f3f80,0xbf753f7b
.long 0x3f35bf80,0xbf35261f,0x3f35bf80,0xbf352804,0x3f35a5d4,0x3f35bf80,0x3f35a7c2,0x3f35bf80,0x3f75bf6d,0xbdc9bf0e,0x3e953ec4,0x3f7fbf55,0x3e953ec4,0x3f7fbf55,0xbf753f6d,0x3dc93f0e
.long 0x3f7bbf35,0x3f0ebf6d,0xbf7b3f35,0xbf0e3f6d,0xbe483f35,0x3f55bec4,0x3e48bf35,0xbf553ec4,0x3f46bec4,0x3f75bf7b,0x3f22bf6d,0xbe95be48,0xbf223f6d,0x3e953e48,0x3f46bec4,0x3f75bf7b
.long 0x3ec4a5f7,0x3f6dbf35,0x3ec4a78d,0x3f6dbf35,0xbf6d3f80,0xbec43f35,0xbf6d3f80,0xbec43f35,0xbdc93ec4,0x3ef1be48,0xbf7f3f6d,0xbf623f7b,0xbf7f3f6d,0xbf623f7b,0x3dc9bec4,0xbef13e48
.long 0xbf0e3f35,0xbe483ec4,0x3f0ebf35,0x3e48bec4,0xbf553f35,0xbf7b3f6d,0x3f55bf35,0x3f7bbf6d,0xbf623f6d,0xbf463f55,0x3ef1bec4,0x3f22bf0e,0xbef13ec4,0xbf223f0e,0xbf623f6d,0xbf463f55
.long 0xbf353f80,0x3f35a742,0xbf353f80,0x3f352754,0xbf352654,0xbf353f80,0xbf35271f,0xbf353f80,0xbf7f3f35,0xbe953f55,0x3dc9bf35,0xbf753f0e,0x3dc9bf35,0xbf753f0e,0x3f7fbf35,0x3e95bf55
.long 0xbf0ea68d,0xbf7b3f6d,0x3f0ea796,0x3f7bbf6d,0x3f55bf80,0xbe48bec4,0xbf553f80,0x3e483ec4,0x3e95bf35,0xbf223e48,0xbf753f35,0xbf463f7b,0x3f75bf35,0x3f46bf7b,0x3e95bf35,0xbf223e48
.long 0x3f6dbf80,0x3ec4bf35,0x3f6dbf80,0x3ec4bf35,0x3ec4a677,0x3f6dbf35,0x3ec4268d,0x3f6dbf35,0x3f62bf35,0x3f7fbf7b,0xbef13f35,0x3dc93e48,0xbef13f35,0x3dc93e48,0xbf623f35,0xbf7f3f7b
.long 0x3e48a742,0x3f0ebec4,0xbe48268d,0xbf0e3ec4,0xbf7b3f80,0xbf553f6d,0x3f7bbf80,0x3f55bf6d,0xbf223f35,0xbef13f0e,0x3f46bf35,0x3f62bf55,0xbf463f35,0xbf623f55,0xbf223f35,0xbef13f0e
.long 0x3f35bf80,0xbf35a60d,0x3f35bf80,0xbf352889,0x3f35a69f,0x3f35bf80,0x3f35268d,0x3f35bf80,0x3f62bec4,0x3f22bf7b,0xbef13f6d,0x3f46be48,0xbef13f6d,0x3f46be48,0xbf623ec4,0xbf223f7b
.long 0xbe483f35,0x3f55bec4,0x3e48bf35,0xbf553ec4,0xbf7b3f35,0xbf0e3f6d,0x3f7bbf35,0x3f0ebf6d,0xbf7f3f6d,0xbef13f55,0x3dc93ec4,0x3f62bf0e,0xbdc9bec4,0xbf623f0e,0xbf7f3f6d,0xbef13f55
.long 0xbec4a60d,0xbf6d3f35,0xbec42816,0xbf6d3f35,0x3f6dbf80,0x3ec4bf35,0x3f6dbf80,0x3ec4bf35,0x3f46bf6d,0x3e95bf0e,0x3f22bec4,0x3f75bf55,0x3f22bec4,0x3f75bf55,0xbf463f6d,0xbe953f0e
.long 0x3f55bf35,0x3f7bbf6d,0xbf553f35,0xbf7b3f6d,0xbf0e3f35,0xbe483ec4,0x3f0ebf35,0x3e48bec4,0xbe953ec4,0xbdc93e48,0x3f75bf6d,0x3f7fbf7b,0xbf753f6d,0xbf7f3f7b,0xbe953ec4,0xbdc93e48
.long 0xbf353f80,0x3f352828,0xbf353f80,0x3f35a7e5,0xbf352754,0xbf353f80,0xbf35279f,0xbf353f80,0x3f46bf80,0xbef1be48,0x3f22a7e5,0x3f62bf7b,0x3f22260e,0x3f62bf7b,0xbf463f80,0x3ef13e48
.long 0xbf553f80,0x3e483ec4,0x3f55bf80,0xbe48bec4,0xbf0ea78d,0xbf7b3f6d,0x3f0ea816,0x3f7bbf6d,0x3f62bf80,0x3dc9bf0e,0xbef12839,0xbf7f3f55,0x3ef1a7f7,0x3f7fbf55,0x3f62bf80,0x3dc9bf0e
.long 0xbf6d3f80,0xbec43f35,0xbf6d3f80,0xbec43f35,0xbec42777,0xbf6d3f35,0xbec4a70d,0xbf6d3f35,0x3f75bf80,0x3f22bf55,0x3e95a880,0x3f46bf0e,0x3e9521b7,0x3f46bf0e,0xbf753f80,0xbf223f55
.long 0xbf7b3f80,0xbf553f6d,0x3f7bbf80,0x3f55bf6d,0xbe482842,0xbf0e3ec4,0x3e48a70d,0x3f0ebec4,0x3f7fbf80,0x3f75bf7b,0xbdc928a3,0xbe953e48,0x3dc9a804,0x3e95be48,0x3f7fbf80,0x3f75bf7b
.long 0x3f35bf80,0xbf35281f,0x3f35bf80,0xbf352839,0x3f35a7f7,0x3f35bf80,0x3f3527d4,0x3f35bf80,0xbf753f6d,0x3dc93f0e,0xbe95bec4,0xbf7f3f55,0xbe95bec4,0xbf7f3f55,0x3f75bf6d,0xbdc9bf0e
.long 0x3f7bbf35,0x3f0ebf6d,0xbf7b3f35,0xbf0e3f6d,0xbe483f35,0x3f55bec4,0x3e48bf35,0xbf553ec4,0xbf463ec4,0xbf753f7b,0xbf223f6d,0x3e953e48,0x3f22bf6d,0xbe95be48,0xbf463ec4,0xbf753f7b
.long 0x3ec426d4,0x3f6dbf35,0x3ec428be,0x3f6dbf35,0xbf6d3f80,0xbec43f35,0xbf6d3f80,0xbec43f35,0x3dc9bec4,0xbef13e48,0x3f7fbf6d,0x3f62bf7b,0x3f7fbf6d,0x3f62bf7b,0xbdc93ec4,0x3ef1be48
.long 0xbf0e3f35,0xbe483ec4,0x3f0ebf35,0x3e48bec4,0xbf553f35,0xbf7b3f6d,0x3f55bf35,0x3f7bbf6d,0x3f62bf6d,0x3f46bf55,0xbef13ec4,0xbf223f0e,0x3ef1bec4,0x3f22bf0e,0x3f62bf6d,0x3f46bf55
.long 0xbf353f80,0x3f3526d4,0xbf353f80,0x3f35a880,0xbf352842,0xbf353f80,0xbf35a70d,0xbf353f80,0x3f7fbf35,0x3e95bf55,0xbdc93f35,0x3f75bf0e,0xbdc93f35,0x3f75bf0e,0xbf7f3f35,0xbe953f55
.long 0xbf0e2828,0xbf7b3f6d,0x3f0ea804,0x3f7bbf6d,0x3f55bf80,0xbe48bec4,0xbf553f80,0x3e483ec4,0xbe953f35,0x3f22be48,0x3f75bf35,0x3f46bf7b,0xbf753f35,0xbf463f7b,0xbe953f35,0x3f22be48
.long 0x3f6dbf80,0x3ec4bf35,0x3f6dbf80,0x3ec4bf35,0x3ec4a80d,0x3f6dbf35,0x3ec4a896,0x3f6dbf35,0xbf623f35,0xbf7f3f7b,0x3ef1bf35,0xbdc9be48,0x3ef1bf35,0xbdc9be48,0x3f62bf35,0x3f7fbf7b
.long 0x3e48a7e5,0x3f0ebec4,0xbe48a731,0xbf0e3ec4,0xbf7b3f80,0xbf553f6d,0x3f7bbf80,0x3f55bf6d,0x3f22bf35,0x3ef1bf0e,0xbf463f35,0xbf623f55,0x3f46bf35,0x3f62bf55,0x3f22bf35,0x3ef1bf0e
.long 0x3f35bf80,0xbf352730,0x3f35bf80,0xbf3528a3,0x3f35a884,0x3f35bf80,0x3f35a909,0x3f35bf80,0xbf623ec4,0xbf223f7b,0x3ef1bf6d,0xbf463e48,0x3ef1bf6d,0xbf463e48,0x3f62bec4,0x3f22bf7b
.long 0xbe483f35,0x3f55bec4,0x3e48bf35,0xbf553ec4,0xbf7b3f35,0xbf0e3f6d,0x3f7bbf35,0x3f0ebf6d,0x3f7fbf6d,0x3ef1bf55,0xbdc9bec4,0xbf623f0e,0x3dc93ec4,0x3f62bf0e,0x3f7fbf6d,0x3ef1bf55
.long 0xbec4289a,0xbf6d3f35,0xbec428ea,0xbf6d3f35,0x3f6dbf80,0x3ec4bf35,0x3f6dbf80,0x3ec4bf35,0xbf463f6d,0xbe953f0e,0xbf223ec4,0xbf753f55,0xbf223ec4,0xbf753f55,0x3f46bf6d,0x3e95bf0e
.long 0x3f55bf35,0x3f7bbf6d,0xbf553f35,0xbf7b3f6d,0xbf0e3f35,0xbe483ec4,0x3f0ebf35,0x3e48bec4,0x3e95bec4,0x3dc9be48,0xbf753f6d,0xbf7f3f7b,0x3f75bf6d,0x3f7fbf7b,0x3e95bec4,0x3dc9be48
.p2align 8
TAB_G1:
.long 0x3a003a00,0x80003a80,0x80003a80,0x80003a80,0xba003a00,0xb8c93a7f,0xb9483a7b,0xb9953a75,0x3a003a00,0xb9483a7b,0xb9c43a6d,0xba0e3a55,0xba003a00,0xb9953a75,0xba0e3a55,0xba463a22
.long 0x3a003a00,0xb9c43a6d,0xba353a35,0xba6d39c4,0xba003a00,0xb9f13a62,0xba553a0e,0xba7f38c9,0x3a003a00,0xba0e3a55,0xba6d39c4,0xba7bb948,0xba003a00,0xba223a46,0xba7b3948,0xba62b9f1
.long 0x3a003a00,0xba353a35,0xba801f8d,0xba35ba35,0xba003a00,0xba463a22,0xba7bb948,0xb9f1ba62,0x3a003a00,0xba553a0e,0xba6db9c4,0xb948ba7b,0xba003a00,0xba6239f1,0xba55ba0e,0x38c9ba7f
.long 0x3a003a00,0xba6d39c4,0xba35ba35,0x39c4ba6d,0xba003a00,0xba753995,0xba0eba55,0x3a22ba46,0x3a003a00,0xba7b3948,0xb9c4ba6d,0x3a55ba0e,0xba003a00,0xba7f38c9,0xb948ba7b,0x3a75b995
.long 0x3a003a00,0xba801f8d,0xa00dba80,0x3a80a054,0xba003a00,0xba7fb8c9,0x3948ba7b,0x3a753995,0x3a003a00,0xba7bb948,0x39c4ba6d,0x3a553a0e,0xba003a00,0xba75b995,0x3a0eba55,0x3a223a46
.long 0x3a003a00,0xba6db9c4,0x3a35ba35,0x39c43a6d,0xba003a00,0xba62b9f1,0x3a55ba0e,0x38c93a7f,0x3a003a00,0xba55ba0e,0x3a6db9c4,0xb9483a7b,0xba003a00,0xba46ba22,0x3a7bb948,0xb9f13a62
.long 0x3a003a00,0xba35ba35,0x3a80a054,0xba353a35,0xba003a00,0xba22ba46,0x3a7b3948,0xba6239f1,0x3a003a00,0xba0eba55,0x3a6d39c4,0xba7b3948,0xba003a00,0xb9f1ba62,0x3a553a0e,0xba7fb8c9
.long 0x3a003a00,0xb9c4ba6d,0x3a353a35,0xba6db9c4,0xba003a00,0xb995ba75,0x3a0e3a55,0xba46ba22,0x3a003a00,0xb948ba7b,0x39c43a6d,0xba0eba55,0xba003a00,0xb8c9ba7f,0x39483a7b,0xb995ba75
.long 0x80003a80,0x80003a80,0x80003a80,0x80003a80,0xb9c43a6d,0xb9f13a62,0xba0e3a55,0xba223a46,0xba353a35,0xba553a0e,0xba6d39c4,0xba7b3948,0xba6d39c4,0xba7f38c9,0xba7bb948,0xba62b9f1
.long 0xba801f8d,0xba6db9c4,0xba35ba35,0xb9c4ba6d,0xba6db9c4,0xba22ba46,0xb948ba7b,0x3995ba75,0xba35ba35,0xb948ba7b,0x39c4ba6d,0x3a55ba0e,0xb9c4ba6d,0x3995ba75,0x3a55ba0e,0x3a7f38c9
.long 0xa00dba80,0x3a35ba35,0x3a80a054,0x3a353a35,0x39c4ba6d,0x3a75b995,0x3a553a0e,0x38c93a7f,0x3a35ba35,0x3a7b3948,0x39c43a6d,0xba0e3a55,0x3a6db9c4,0x3a463a22,0xb9483a7b,0xba753995
.long 0x3a80a054,0x39c43a6d,0xba353a35,0xba6db9c4,0x3a6d39c4,0xb8c93a7f,0xba7b3948,0xb9f1ba62,0x3a353a35,0xba0e3a55,0xba6db9c4,0x3948ba7b,0x39c43a6d,0xba6239f1,0xba0eba55,0x3a46ba22
.long 0x208d3a80,0xba8020b0,0xa0d4ba80,0x3a80a0f7,0xb9c43a6d,0xba62b9f1,0x3a0eba55,0x3a463a22,0xba353a35,0xba0eba55,0x3a6db9c4,0x39483a7b,0xba6d39c4,0xb8c9ba7f,0x3a7b3948,0xb9f13a62
.long 0xba8020b0,0x39c4ba6d,0x3a353a35,0xba6d39c4,0xba6db9c4,0x3a46ba22,0x39483a7b,0xba75b995,0xba35ba35,0x3a7bb948,0xb9c43a6d,0xba0eba55,0xb9c4ba6d,0x3a753995,0xba553a0e,0x38c9ba7f
.long 0xa0d4ba80,0x3a353a35,0xba80211f,0x3a35ba35,0x39c4ba6d,0x39953a75,0xba55ba0e,0x3a7fb8c9,0x3a35ba35,0xb9483a7b,0xb9c4ba6d,0x3a553a0e,0x3a6db9c4,0xba223a46,0x3948ba7b,0x39953a75
.long 0x3a80a0f7,0xba6d39c4,0x3a35ba35,0xb9c43a6d,0x3a6d39c4,0xba7fb8c9,0x3a7bb948,0xba6239f1,0x3a353a35,0xba55ba0e,0x3a6d39c4,0xba7bb948,0x39c43a6d,0xb9f1ba62,0x3a0e3a55,0xba22ba46
.long 0x80003a80,0x80003a80,0x80003a80,0x80003a80,0xba353a35,0xba463a22,0xba553a0e,0xba6239f1,0xba801f8d,0xba7bb948,0xba6db9c4,0xba55ba0e,0xba35ba35,0xb9f1ba62,0xb948ba7b,0x38c9ba7f
.long 0xa00dba80,0x39c4ba6d,0x3a35ba35,0x3a6db9c4,0x3a35ba35,0x3a75b995,0x3a7b3948,0x3a463a22,0x3a80a054,0x3a553a0e,0x39c43a6d,0xb9483a7b,0x3a353a35,0x38c93a7f,0xba0e3a55,0xba753995
.long 0x208d3a80,0xba353a35,0xba8020b0,0xba35ba35,0xba353a35,0xba7fb8c9,0xba0eba55,0x3995ba75,0xba8020b0,0xba0eba55,0x39c4ba6d,0x3a7bb948,0xba35ba35,0x3995ba75,0x3a7bb948,0x3a223a46
.long 0xa0d4ba80,0x3a6db9c4,0x3a353a35,0xb9c43a6d,0x3a35ba35,0x3a6239f1,0xb9483a7b,0xba7f38c9,0x3a80a0f7,0x39483a7b,0xba6d39c4,0xba0eba55,0x3a353a35,0xba223a46,0xba55ba0e,0x39f1ba62
.long 0x210d3a80,0xba80211f,0xa130ba80,0x3a80a231,0xba353a35,0xba22ba46,0x3a55ba0e,0x39f13a62,0xba80211f,0x3948ba7b,0x3a6d39c4,0xba0e3a55,0xba35ba35,0x3a62b9f1,0x39483a7b,0xba7fb8c9
.long 0xa130ba80,0x3a6d39c4,0xba353a35,0xb9c4ba6d,0x3a35ba35,0x39953a75,0xba7bb948,0x3a22ba46,0x3a80a231,0xba0e3a55,0xb9c4ba6d,0x3a7b3948,0x3a353a35,0xba7f38c9,0x3a0eba55,0x39953a75
.long 0x21543a80,0xba35ba35,0x3a80a242,0xba353a35,0xba353a35,0x38c9ba7f,0x3a0e3a55,0xba75b995,0xba80a18d,0x3a55ba0e,0xb9c43a6d,0xb948ba7b,0xba35ba35,0x3a753995,0xba7b3948,0x3a46ba22
.long 0xa177ba80,0x39c43a6d,0xba35ba35,0x3a6d39c4,0x3a35ba35,0xb9f13a62,0x3948ba7b,0x38c93a7f,0x3a80a242,0xba7b3948,0x3a6db9c4,0xba553a0e,0x3a353a35,0xba46ba22,0x3a553a0e,0xba62b9f1
.long 0x80003a80,0x80003a80,0x80003a80,0x80003a80,0xba6d39c4,0xba753995,0xba7b3948,0xba7f38c9,0xba35ba35,0xba0eba55,0xb9c4ba6d,0xb948ba7b,0x39c4ba6d,0x3a22ba46,0x3a55ba0e,0x3a75b995
.long 0x3a80a054,0x3a6d39c4,0x3a353a35,0x39c43a6d,0x39c43a6d,0xb8c93a7f,0xba0e3a55,0xba6239f1,0xba353a35,0xba7b3948,0xba6db9c4,0xba0eba55,0xba6db9c4,0xb9f1ba62,0x3948ba7b,0x3a46ba22
.long 0xa0d4ba80,0x3a35ba35,0x3a80a0f7,0x3a353a35,0x3a6db9c4,0x3a6239f1,0x39483a7b,0xba223a46,0x3a353a35,0xb9483a7b,0xba6d39c4,0xba55ba0e,0xb9c43a6d,0xba7f38c9,0xba0eba55,0x39f1ba62
.long 0xba80211f,0xb9c4ba6d,0x3a35ba35,0x3a6d39c4,0xb9c4ba6d,0x3a46ba22,0x3a553a0e,0xb9953a75,0x3a35ba35,0x3a553a0e,0xb9c43a6d,0xba7bb948,0x3a6d39c4,0xb9953a75,0xba7bb948,0x38c9ba7f
.long 0x21543a80,0xba80a18d,0xa177ba80,0x3a80a242,0xba6d39c4,0xb995ba75,0x3a7bb948,0x38c93a7f,0xba35ba35,0x3a55ba0e,0x39c43a6d,0xba7b3948,0x39c4ba6d,0x3a463a22,0xba553a0e,0xb995ba75
.long 0x3a80a242,0xb9c43a6d,0xba35ba35,0x3a6db9c4,0x39c43a6d,0xba7fb8c9,0x3a0eba55,0x39f13a62,0xba353a35,0xb948ba7b,0x3a6d39c4,0xba553a0e,0xba6db9c4,0x3a62b9f1,0xb9483a7b,0xba22ba46
.long 0xa19fba80,0x3a353a35,0xba80a10d,0x3a35ba35,0x3a6db9c4,0xb9f13a62,0xb948ba7b,0x3a463a22,0x3a353a35,0xba7bb948,0x3a6db9c4,0xba0e3a55,0xb9c43a6d,0xb8c9ba7f,0x3a0e3a55,0xba62b9f1
.long 0xba80a10d,0x3a6db9c4,0xba353a35,0x39c4ba6d,0xb9c4ba6d,0x3a223a46,0xba55ba0e,0x3a753995,0x3a35ba35,0xba0e3a55,0x39c4ba6d,0xb9483a7b,0x3a6d39c4,0xba75b995,0x3a7b3948,0xba7fb8c9
.long 0x80003a80,0x80003a80,0x80003a80,0x80003a80,0xba801f8d,0xba7fb8c9,0xba7bb948,0xba75b995,0xa00dba80,0x3948ba7b,0x39c4ba6d,0x3a0eba55,0x3a80a054,0x3a753995,0x3a553a0e,0x3a223a46
.long 0x208d3a80,0xb9c43a6d,0xba353a35,0xba6d39c4,0xba8020b0,0xba62b9f1,0xba0eba55,0xb8c9ba7f,0xa0d4ba80,0x3a0eba55,0x3a6db9c4,0x3a7b3948,0x3a80a0f7,0x3a463a22,0x39483a7b,0xb9f13a62
.long 0x210d3a80,0xba353a35,0xba80211f,0xba35ba35,0xba80211f,0xba22ba46,0x3948ba7b,0x3a62b9f1,0xa130ba80,0x3a55ba0e,0x3a6d39c4,0x39483a7b,0x3a80a231,0x39f13a62,0xba0e3a55,0xba7fb8c9
.long 0x21543a80,0xba6d39c4,0xba35ba35,0x39c4ba6d,0xba80a18d,0xb995ba75,0x3a55ba0e,0x3a463a22,0xa177ba80,0x3a7bb948,0x39c43a6d,0xba553a0e,0x3a80a242,0x38c93a7f,0xba7b3948,0xb995ba75
.long 0x218d3a80,0xba80a154,0xa19fba80,0x3a80a254,0xba80a154,0x38c9ba7f,0x3a7b3948,0xb9953a75,0xa19fba80,0x3a7b3948,0xb9c43a6d,0xba55ba0e,0x3a80a254,0xb9953a75,0xba55ba0e,0x3a46ba22
.long 0x21b03a80,0xba6db9c4,0x3a35ba35,0x39c43a6d,0xba80a10d,0x39f1ba62,0x3a0e3a55,0xba7f38c9,0xa2b1ba80,0x3a553a0e,0xba6d39c4,0x3948ba7b,0x3a80a265,0xba223a46,0xb948ba7b,0x3a6239f1
.long 0x21d43a80,0xba35ba35,0x3a80a277,0xba353a35,0xba80a08e,0x3a46ba22,0xb9483a7b,0xb9f1ba62,0x220dba80,0x3a0e3a55,0xba6db9c4,0x3a7bb948,0x3a80a277,0xba6239f1,0x3a0eba55,0xb8c93a7f
.long 0x21f73a80,0xb9c4ba6d,0x3a353a35,0xba6db9c4,0xba809c37,0x3a75b995,0xba553a0e,0x3a22ba46,0xa2c2ba80,0x39483a7b,0xb9c4ba6d,0x3a0e3a55,0x3a80a284,0xba7f38c9,0x3a7bb948,0xba753995
.long 0x80003a80,0x80003a80,0x80003a80,0x80003a80,0xba6db9c4,0xba62b9f1,0xba55ba0e,0xba46ba22,0x3a35ba35,0x3a55ba0e,0x3a6db9c4,0x3a7bb948,0x39c43a6d,0x38c93a7f,0xb9483a7b,0xb9f13a62
.long 0xba8020b0,0xba6db9c4,0xba35ba35,0xb9c4ba6d,0x39c4ba6d,0x3a46ba22,0x3a7bb948,0x3a753995,0x3a353a35,0x39483a7b,0xb9c43a6d,0xba553a0e,0xba6d39c4,0xba75b995,0xba0eba55,0x38c9ba7f
.long 0xa130ba80,0x3a35ba35,0x3a80a231,0x3a353a35,0x3a6d39c4,0x39953a75,0xba0e3a55,0xba7f38c9,0xba353a35,0xba7bb948,0xb9c4ba6d,0x3a0eba55,0xb9c4ba6d,0x3a22ba46,0x3a7b3948,0x39953a75
.long 0x3a80a242,0x39c43a6d,0xba353a35,0xba6db9c4,0xb9c43a6d,0xba7fb8c9,0xb948ba7b,0x3a62b9f1,0xba35ba35,0x3a0eba55,0x3a6d39c4,0xb9483a7b,0x3a6db9c4,0x39f13a62,0xba553a0e,0xba22ba46
.long 0x21b03a80,0xba80a10d,0xa2b1ba80,0x3a80a265,0xba6db9c4,0x39f1ba62,0x3a553a0e,0xba223a46,0x3a35ba35,0x3a0e3a55,0xba6d39c4,0xb948ba7b,0x39c43a6d,0xba7f38c9,0x3948ba7b,0x3a6239f1
.long 0xba80a08e,0x39c4ba6d,0x3a353a35,0xba6d39c4,0x39c4ba6d,0x3a223a46,0xba7b3948,0x3995ba75,0x3a353a35,0xba7b3948,0x39c4ba6d,0x3a0e3a55,0xba6d39c4,0x3995ba75,0x3a0e3a55,0xba7fb8c9
.long 0xa2c2ba80,0x3a353a35,0xba80208d,0x3a35ba35,0x3a6d39c4,0xba753995,0x3a0eba55,0x38c93a7f,0xba353a35,0x3948ba7b,0x39c43a6d,0xba55ba0e,0xb9c4ba6d,0x3a463a22,0xba7bb948,0x3a75b995
.long 0x3a80a28d,0xba6d39c4,0x3a35ba35,0xb9c43a6d,0xb9c43a6d,0x38c9ba7f,0x39483a7b,0xb9f1ba62,0xba35ba35,0x3a553a0e,0xba6db9c4,0x3a7b3948,0x3a6db9c4,0xba6239f1,0x3a55ba0e,0xba463a22
.long 0x80003a80,0x80003a80,0x80003a80,0x80003a80,0xba35ba35,0xba22ba46,0xba0eba55,0xb9f1ba62,0x3a80a054,0x3a7b3948,0x3a6d39c4,0x3a553a0e,0xba353a35,0xba6239f1,0xba7b3948,0xba7fb8c9
.long 0xa0d4ba80,0x39c4ba6d,0x3a35ba35,0x3a6db9c4,0x3a353a35,0x39953a75,0xb9483a7b,0xba223a46,0xba80211f,0xba55ba0e,0xb9c4ba6d,0x3948ba7b,0x3a35ba35,0x3a7fb8c9,0x3a553a0e,0x39953a75
.long 0x21543a80,0xba353a35,0xba80a18d,0xba35ba35,0xba35ba35,0x38c9ba7f,0x3a55ba0e,0x3a753995,0x3a80a242,0x3a0e3a55,0xb9c43a6d,0xba7b3948,0xba353a35,0xba75b995,0xb948ba7b,0x3a46ba22
.long 0xa19fba80,0x3a6db9c4,0x3a353a35,0xb9c43a6d,0x3a353a35,0xb9f13a62,0xba7bb948,0xb8c9ba7f,0xba80a10d,0xb948ba7b,0x3a6db9c4,0x3a0e3a55,0x3a35ba35,0x3a463a22,0xba0e3a55,0xba62b9f1
.long 0x21d43a80,0xba80a08e,0x220dba80,0x3a80a277,0xba35ba35,0x3a46ba22,0x3a0e3a55,0xba6239f1,0x3a80a277,0xb9483a7b,0xba6db9c4,0x3a0eba55,0xba353a35,0xb9f1ba62,0x3a7bb948,0xb8c93a7f
.long 0xa2c2ba80,0x3a6d39c4,0xba353a35,0xb9c4ba6d,0x3a353a35,0xba753995,0x3948ba7b,0x3a463a22,0xba802304,0x3a0eba55,0x39c43a6d,0xba7bb948,0x3a35ba35,0x38c93a7f,0xba55ba0e,0x3a75b995
.long 0x221f3a80,0xba35ba35,0x3a80a296,0xba353a35,0xba35ba35,0x3a7f38c9,0xba553a0e,0x3995ba75,0x3a802254,0xba553a0e,0x39c4ba6d,0x39483a7b,0xba353a35,0x3995ba75,0x39483a7b,0xba22ba46
.long 0x218dba80,0x39c43a6d,0xba35ba35,0x3a6d39c4,0x3a353a35,0xba62b9f1,0x3a7b3948,0xba7f38c9,0xba802389,0x3a7bb948,0xba6d39c4,0x3a55ba0e,0x3a35ba35,0xba223a46,0x3a0eba55,0xb9f13a62
.long 0x80003a80,0x80003a80,0x80003a80,0x80003a80,0xb9c4ba6d,0xb995ba75,0xb948ba7b,0xb8c9ba7f,0x3a353a35,0x3a0e3a55,0x39c43a6d,0x39483a7b,0xba6db9c4,0xba46ba22,0xba0eba55,0xb995ba75
.long 0x3a80a0f7,0x3a6d39c4,0x3a353a35,0x39c43a6d,0xba6d39c4,0xba7fb8c9,0xba55ba0e,0xb9f1ba62,0x3a35ba35,0x3a7bb948,0x3a6d39c4,0x3a0e3a55,0xb9c43a6d,0xba6239f1,0xba7bb948,0xba22ba46
.long 0xa177ba80,0x3a35ba35,0x3a80a242,0x3a353a35,0x39c43a6d,0xb9f13a62,0xba7b3948,0xba46ba22,0xba35ba35,0x3948ba7b,0x3a6db9c4,0x3a553a0e,0x3a6d39c4,0x38c93a7f,0xba553a0e,0xba62b9f1
.long 0xba80a10d,0xb9c4ba6d,0x3a35ba35,0x3a6d39c4,0x3a6db9c4,0x3a223a46,0xba0e3a55,0xba75b995,0xba353a35,0xba55ba0e,0x39c4ba6d,0x3a7b3948,0x39c4ba6d,0x3a753995,0xb9483a7b,0xba7fb8c9
.long 0x21f73a80,0xba809c37,0xa2c2ba80,0x3a80a284,0xb9c4ba6d,0x3a75b995,0x39483a7b,0xba7f38c9,0x3a353a35,0xba553a0e,0xb9c4ba6d,0x3a7bb948,0xba6db9c4,0x3a22ba46,0x3a0e3a55,0xba753995
.long 0x3a80a28d,0xb9c43a6d,0xba35ba35,0x3a6db9c4,0xba6d39c4,0x38c9ba7f,0x3a553a0e,0xba6239f1,0x3a35ba35,0x39483a7b,0xba6db9c4,0x3a55ba0e,0xb9c43a6d,0xb9f1ba62,0x3a7b3948,0xba463a22
.long 0x218dba80,0x3a353a35,0xba80218d,0x3a35ba35,0x39c43a6d,0xba62b9f1,0x3a7bb948,0xba223a46,0xba35ba35,0x3a7b3948,0xba6d39c4,0x3a0eba55,0x3a6d39c4,0xba7f38c9,0x3a55ba0e,0xb9f13a62
.long 0xba802316,0x3a6db9c4,0xba353a35,0x39c4ba6d,0x3a6db9c4,0xba463a22,0x3a0eba55,0xb9953a75,0xba353a35,0x3a0eba55,0xb9c43a6d,0x3948ba7b,0x39c4ba6d,0xb9953a75,0x3948ba7b,0xb8c93a7f
.long 0x3a003a00,0xa00dba80,0x208d3a80,0xa0d4ba80,0xba003a00,0x38c9ba7f,0xb9483a7b,0x3995ba75,0x3a003a00,0x3948ba7b,0xb9c43a6d,0x3a0eba55,0xba003a00,0x3995ba75,0xba0e3a55,0x3a46ba22
.long 0x3a003a00,0x39c4ba6d,0xba353a35,0x3a6db9c4,0xba003a00,0x39f1ba62,0xba553a0e,0x3a7fb8c9,0x3a003a00,0x3a0eba55,0xba6d39c4,0x3a7b3948,0xba003a00,0x3a22ba46,0xba7b3948,0x3a6239f1
.long 0x3a003a00,0x3a35ba35,0xba8020b0,0x3a353a35,0xba003a00,0x3a46ba22,0xba7bb948,0x39f13a62,0x3a003a00,0x3a55ba0e,0xba6db9c4,0x39483a7b,0xba003a00,0x3a62b9f1,0xba55ba0e,0xb8c93a7f
.long 0x3a003a00,0x3a6db9c4,0xba35ba35,0xb9c43a6d,0xba003a00,0x3a75b995,0xba0eba55,0xba223a46,0x3a003a00,0x3a7bb948,0xb9c4ba6d,0xba553a0e,0xba003a00,0x3a7fb8c9,0xb948ba7b,0xba753995
.long 0x3a003a00,0x3a80a054,0xa0d4ba80,0xba80211f,0xba003a00,0x3a7f38c9,0x3948ba7b,0xba75b995,0x3a003a00,0x3a7b3948,0x39c4ba6d,0xba55ba0e,0xba003a00,0x3a753995,0x3a0eba55,0xba22ba46
.long 0x3a003a00,0x3a6d39c4,0x3a35ba35,0xb9c4ba6d,0xba003a00,0x3a6239f1,0x3a55ba0e,0xb8c9ba7f,0x3a003a00,0x3a553a0e,0x3a6db9c4,0x3948ba7b,0xba003a00,0x3a463a22,0x3a7bb948,0x39f1ba62
.long 0x3a003a00,0x3a353a35,0x3a80a0f7,0x3a35ba35,0xba003a00,0x3a223a46,0x3a7b3948,0x3a62b9f1,0x3a003a00,0x3a0e3a55,0x3a6d39c4,0x3a7bb948,0xba003a00,0x39f13a62,0x3a553a0e,0x3a7f38c9
.long 0x3a003a00,0x39c43a6d,0x3a353a35,0x3a6d39c4,0xba003a00,0x39953a75,0x3a0e3a55,0x3a463a22,0x3a003a00,0x39483a7b,0x39c43a6d,0x3a0e3a55,0xba003a00,0x38c93a7f,0x39483a7b,0x39953a75
.long 0x210d3a80,0xa130ba80,0x21543a80,0xa177ba80,0xb9c43a6d,0x39f1ba62,0xba0e3a55,0x3a22ba46,0xba353a35,0x3a55ba0e,0xba6d39c4,0x3a7bb948,0xba6d39c4,0x3a7fb8c9,0xba7bb948,0x3a6239f1
.long 0xba80211f,0x3a6d39c4,0xba35ba35,0x39c43a6d,0xba6db9c4,0x3a223a46,0xb948ba7b,0xb9953a75,0xba35ba35,0x39483a7b,0x39c4ba6d,0xba553a0e,0xb9c4ba6d,0xb9953a75,0x3a55ba0e,0xba7fb8c9
.long 0xa130ba80,0xba353a35,0x3a80a242,0xba35ba35,0x39c4ba6d,0xba753995,0x3a553a0e,0xb8c9ba7f,0x3a35ba35,0xba7bb948,0x39c43a6d,0x3a0eba55,0x3a6db9c4,0xba46ba22,0xb9483a7b,0x3a75b995
.long 0x3a80a231,0xb9c4ba6d,0xba353a35,0x3a6d39c4,0x3a6d39c4,0x38c9ba7f,0xba7b3948,0x39f13a62,0x3a353a35,0x3a0eba55,0xba6db9c4,0xb9483a7b,0x39c43a6d,0x3a62b9f1,0xba0eba55,0xba463a22
.long 0x21543a80,0x3a80a242,0xa19fba80,0xba80a10d,0xb9c43a6d,0x3a6239f1,0x3a0eba55,0xba46ba22,0xba353a35,0x3a0e3a55,0x3a6db9c4,0xb948ba7b,0xba6d39c4,0x38c93a7f,0x3a7b3948,0x39f1ba62
.long 0xba80a18d,0xb9c43a6d,0x3a353a35,0x3a6db9c4,0xba6db9c4,0xba463a22,0x39483a7b,0x3a753995,0xba35ba35,0xba7b3948,0xb9c43a6d,0x3a0e3a55,0xb9c4ba6d,0xba75b995,0xba553a0e,0xb8c93a7f
.long 0xa177ba80,0xba35ba35,0xba80a10d,0xba353a35,0x39c4ba6d,0xb995ba75,0xba55ba0e,0xba7f38c9,0x3a35ba35,0x3948ba7b,0xb9c4ba6d,0xba55ba0e,0x3a6db9c4,0x3a22ba46,0x3948ba7b,0xb995ba75
.long 0x3a80a242,0x3a6db9c4,0x3a35ba35,0x39c4ba6d,0x3a6d39c4,0x3a7f38c9,0x3a7bb948,0x3a62b9f1,0x3a353a35,0x3a553a0e,0x3a6d39c4,0x3a7b3948,0x39c43a6d,0x39f13a62,0x3a0e3a55,0x3a223a46
.long 0x218d3a80,0xa19fba80,0x21b03a80,0xa2b1ba80,0xba353a35,0x3a46ba22,0xba553a0e,0x3a62b9f1,0xba80a154,0x3a7b3948,0xba6db9c4,0x3a553a0e,0xba35ba35,0x39f13a62,0xb948ba7b,0xb8c93a7f
.long 0xa19fba80,0xb9c43a6d,0x3a35ba35,0xba6d39c4,0x3a35ba35,0xba753995,0x3a7b3948,0xba46ba22,0x3a80a254,0xba55ba0e,0x39c43a6d,0x3948ba7b,0x3a353a35,0xb8c9ba7f,0xba0e3a55,0x3a75b995
.long 0x21b03a80,0x3a35ba35,0xba80a08e,0x3a353a35,0xba353a35,0x3a7f38c9,0xba0eba55,0xb9953a75,0xba80a10d,0x3a0e3a55,0x39c4ba6d,0xba7b3948,0xba35ba35,0xb9953a75,0x3a7bb948,0xba22ba46
.long 0xa2b1ba80,0xba6d39c4,0x3a353a35,0x39c4ba6d,0x3a35ba35,0xba62b9f1,0xb9483a7b,0x3a7fb8c9,0x3a80a265,0xb948ba7b,0xba6d39c4,0x3a0e3a55,0x3a353a35,0x3a22ba46,0xba55ba0e,0xb9f13a62
.long 0x21d43a80,0x3a80a277,0xa2c2ba80,0xba80208d,0xba353a35,0x3a223a46,0x3a55ba0e,0xb9f1ba62,0xba80a08e,0xb9483a7b,0x3a6d39c4,0x3a0eba55,0xba35ba35,0xba6239f1,0x39483a7b,0x3a7f38c9
.long 0x220dba80,0xba6db9c4,0xba353a35,0x39c43a6d,0x3a35ba35,0xb995ba75,0xba7bb948,0xba223a46,0x3a80a277,0x3a0eba55,0xb9c4ba6d,0xba7bb948,0x3a353a35,0x3a7fb8c9,0x3a0eba55,0xb995ba75
.long 0x21f73a80,0x3a353a35,0x3a80a28d,0x3a35ba35,0xba353a35,0xb8c93a7f,0x3a0e3a55,0x3a753995,0xba809c37,0xba553a0e,0xb9c43a6d,0x39483a7b,0xba35ba35,0xba75b995,0xba7b3948,0xba463a22
.long 0xa2c2ba80,0xb9c4ba6d,0xba35ba35,0xba6db9c4,0x3a35ba35,0x39f1ba62,0x3948ba7b,0xb8c9ba7f,0x3a80a284,0x3a7bb948,0x3a6db9c4,0x3a55ba0e,0x3a353a35,0x3a463a22,0x3a553a0e,0x3a6239f1
.long 0x21d43a80,0x220dba80,0x21f73a80,0xa2c2ba80,0xba6d39c4,0x3a75b995,0xba7b3948,0x3a7fb8c9,0xba35ba35,0x3a0e3a55,0xb9c4ba6d,0x39483a7b,0x39c4ba6d,0xba223a46,0x3a55ba0e,0xba753995
.long 0x3a80a277,0xba6db9c4,0x3a353a35,0xb9c4ba6d,0x39c43a6d,0x38c9ba7f,0xba0e3a55,0x3a62b9f1,0xba353a35,0x3a7bb948,0xba6db9c4,0x3a0e3a55,0xba6db9c4,0x39f13a62,0x3948ba7b,0xba463a22
.long 0xa2c2ba80,0xba353a35,0x3a80a28d,0xba35ba35,0x3a6db9c4,0xba62b9f1,0x39483a7b,0x3a22ba46,0x3a353a35,0x3948ba7b,0xba6d39c4,0x3a553a0e,0xb9c43a6d,0x3a7fb8c9,0xba0eba55,0xb9f13a62
.long 0xba802304,0x39c43a6d,0x3a35ba35,0xba6db9c4,0xb9c4ba6d,0xba463a22,0x3a553a0e,0x3995ba75,0x3a35ba35,0xba55ba0e,0xb9c43a6d,0x3a7b3948,0x3a6d39c4,0x3995ba75,0xba7bb948,0xb8c93a7f
.long 0x221f3a80,0x3a80a296,0x218dba80,0xba80218d,0xba6d39c4,0x39953a75,0x3a7bb948,0xb8c9ba7f,0xba35ba35,0xba553a0e,0x39c43a6d,0x3a7bb948,0x39c4ba6d,0xba46ba22,0xba553a0e,0x39953a75
.long 0x3a802254,0x39c4ba6d,0xba35ba35,0xba6d39c4,0x39c43a6d,0x3a7f38c9,0x3a0eba55,0xb9f1ba62,0xba353a35,0x39483a7b,0x3a6d39c4,0x3a55ba0e,0xba6db9c4,0xba6239f1,0xb9483a7b,0x3a223a46
.long 0x218dba80,0xba35ba35,0xba802316,0xba353a35,0x3a6db9c4,0x39f1ba62,0xb948ba7b,0xba46ba22,0x3a353a35,0x3a7b3948,0x3a6db9c4,0x3a0eba55,0xb9c43a6d,0x38c93a7f,0x3a0e3a55,0x3a6239f1
.long 0xba802389,0xba6d39c4,0xba353a35,0xb9c43a6d,0xb9c4ba6d,0xba22ba46,0xba55ba0e,0xba75b995,0x3a35ba35,0x3a0eba55,0x39c4ba6d,0x3948ba7b,0x3a6d39c4,0x3a753995,0x3a7b3948,0x3a7f38c9
.long 0x220d3a80,0x21d4ba80,0x221f3a80,0xa2d4ba80,0xba80208d,0x3a7f38c9,0xba7bb948,0x3a753995,0x21d4ba80,0xb9483a7b,0x39c4ba6d,0xba0e3a55,0x3a80a28d,0xba75b995,0x3a553a0e,0xba22ba46
.long 0x221f3a80,0x39c4ba6d,0xba353a35,0x3a6db9c4,0xba80210d,0x3a6239f1,0xba0eba55,0x38c93a7f,0xa2d4ba80,0xba0e3a55,0x3a6db9c4,0xba7bb948,0x3a80a296,0xba46ba22,0x39483a7b,0x39f1ba62
.long 0x22303a80,0x3a35ba35,0xba80218d,0x3a353a35,0xba80230d,0x3a223a46,0x3948ba7b,0xba6239f1,0x218dba80,0xba553a0e,0x3a6d39c4,0xb948ba7b,0x3a80a29f,0xb9f1ba62,0xba0e3a55,0x3a7f38c9
.long 0x23313a80,0x3a6db9c4,0xba35ba35,0xb9c43a6d,0xba80218d,0x39953a75,0x3a55ba0e,0xba46ba22,0xa2e5ba80,0xba7b3948,0x39c43a6d,0x3a55ba0e,0x3a802231,0xb8c9ba7f,0xba7b3948,0x39953a75
.long 0x22543a80,0x3a80a2b1,0xa2f7ba80,0xba80231f,0xba802316,0xb8c93a7f,0x3a7b3948,0x3995ba75,0x210eba80,0xba7bb948,0xb9c43a6d,0x3a553a0e,0x3a80a2b1,0x3995ba75,0xba55ba0e,0xba463a22
.long 0xa28d3a80,0x3a6d39c4,0x3a35ba35,0xb9c4ba6d,0xba8021d4,0xb9f13a62,0x3a0e3a55,0x3a7fb8c9,0xa2f7ba80,0xba55ba0e,0xba6d39c4,0xb9483a7b,0x3a80220d,0x3a22ba46,0xb948ba7b,0xba62b9f1
.long 0x22773a80,0x3a353a35,0x3a8021d4,0x3a35ba35,0xba80231f,0xba463a22,0xb9483a7b,0x39f13a62,0x1cb7ba80,0xba0eba55,0xba6db9c4,0xba7b3948,0x3a80a2c2,0x3a62b9f1,0x3a0eba55,0x38c9ba7f
.long 0x23423a80,0x39c43a6d,0x3a353a35,0x3a6d39c4,0xba80220d,0xba753995,0xba553a0e,0xba223a46,0xa304ba80,0xb948ba7b,0xb9c4ba6d,0xba0eba55,0x3a8021d4,0x3a7fb8c9,0x3a7bb948,0x3a75b995
.long 0x22303a80,0x218dba80,0x23313a80,0xa2e5ba80,0xba6db9c4,0x3a6239f1,0xba55ba0e,0x3a463a22,0x3a35ba35,0xba553a0e,0x3a6db9c4,0xba7b3948,0x39c43a6d,0xb8c9ba7f,0xb9483a7b,0x39f1ba62
.long 0xba80218d,0x3a6d39c4,0xba35ba35,0x39c43a6d,0x39c4ba6d,0xba463a22,0x3a7bb948,0xba75b995,0x3a353a35,0xb948ba7b,0xb9c43a6d,0x3a55ba0e,0xba6d39c4,0x3a753995,0xba0eba55,0xb8c93a7f
.long 0x210eba80,0xba353a35,0x3a80220d,0xba35ba35,0x3a6d39c4,0xb995ba75,0xba0e3a55,0x3a7fb8c9,0xba353a35,0x3a7b3948,0xb9c4ba6d,0xba0e3a55,0xb9c4ba6d,0xba223a46,0x3a7b3948,0xb995ba75
.long 0x3a80a35d,0xb9c4ba6d,0xba353a35,0x3a6d39c4,0xb9c43a6d,0x3a7f38c9,0xb948ba7b,0xba6239f1,0xba35ba35,0xba0e3a55,0x3a6d39c4,0x3948ba7b,0x3a6db9c4,0xb9f1ba62,0xba553a0e,0x3a223a46
.long 0x23423a80,0x3a8021d4,0xa10dba80,0xba802230,0xba6db9c4,0xb9f13a62,0x3a553a0e,0x3a22ba46,0x3a35ba35,0xba0eba55,0xba6d39c4,0x39483a7b,0x39c43a6d,0x3a7fb8c9,0x3948ba7b,0xba62b9f1
.long 0xba80a2b1,0xb9c43a6d,0x3a353a35,0x3a6db9c4,0x39c4ba6d,0xba22ba46,0xba7b3948,0xb9953a75,0x3a353a35,0x3a7bb948,0x39c4ba6d,0xba0eba55,0xba6d39c4,0xb9953a75,0x3a0e3a55,0x3a7f38c9
.long 0xa30dba80,0xba35ba35,0xba802254,0xba353a35,0x3a6d39c4,0x3a75b995,0x3a0eba55,0xb8c9ba7f,0xba353a35,0xb9483a7b,0x39c43a6d,0x3a553a0e,0xb9c4ba6d,0xba46ba22,0xba7bb948,0xba753995
.long 0x3a80a2e5,0x3a6db9c4,0x3a35ba35,0x39c4ba6d,0xb9c43a6d,0xb8c93a7f,0x39483a7b,0x39f13a62,0xba35ba35,0xba55ba0e,0xba6db9c4,0xba7bb948,0x3a6db9c4,0x3a62b9f1,0x3a55ba0e,0x3a46ba22
.long 0x22543a80,0x210eba80,0xa28d3a80,0xa2f7ba80,0xba35ba35,0x3a223a46,0xba0eba55,0x39f13a62,0x3a802328,0xba7bb948,0x3a6d39c4,0xba55ba0e,0xba353a35,0x3a62b9f1,0xba7b3948,0x3a7f38c9
.long 0xa2f7ba80,0xb9c43a6d,0x3a35ba35,0xba6d39c4,0x3a353a35,0xb995ba75,0xb9483a7b,0x3a22ba46,0xba80231f,0x3a553a0e,0xb9c4ba6d,0xb9483a7b,0x3a35ba35,0xba7f38c9,0x3a553a0e,0xb995ba75
.long 0x23423a80,0x3a35ba35,0xba802328,0x3a353a35,0xba35ba35,0xb8c93a7f,0x3a55ba0e,0xba75b995,0x3a8021d4,0xba0eba55,0xb9c43a6d,0x3a7bb948,0xba353a35,0x3a753995,0xb948ba7b,0xba463a22
.long 0xa384ba80,0xba6d39c4,0x3a353a35,0x39c4ba6d,0x3a353a35,0x39f1ba62,0xba7bb948,0x38c93a7f,0xba802230,0x39483a7b,0x3a6db9c4,0xba0eba55,0x3a35ba35,0xba46ba22,0xba0e3a55,0x3a6239f1
.long 0x229f3a80,0x3a80a2e5,0xa316ba80,0xba802339,0xba35ba35,0xba463a22,0x3a0e3a55,0x3a62b9f1,0x3a80a2e5,0x3948ba7b,0xba6db9c4,0xba0e3a55,0xba353a35,0x39f13a62,0x3a7bb948,0x38c9ba7f
.long 0x22d4ba80,0xba6db9c4,0xba353a35,0x39c43a6d,0x3a353a35,0x3a75b995,0x3948ba7b,0xba46ba22,0xba802339,0xba0e3a55,0x39c43a6d,0x3a7b3948,0x3a35ba35,0xb8c9ba7f,0xba55ba0e,0xba753995
.long 0xa20d3a80,0x3a353a35,0x3a80a304,0x3a35ba35,0xba35ba35,0xba7fb8c9,0xba553a0e,0xb9953a75,0x3a80a380,0x3a55ba0e,0x39c4ba6d,0xb948ba7b,0xba353a35,0xb9953a75,0x39483a7b,0x3a223a46
.long 0xa409ba80,0xb9c4ba6d,0xba35ba35,0xba6db9c4,0x3a353a35,0x3a6239f1,0x3a7b3948,0x3a7fb8c9,0xba8023a3,0xba7b3948,0xba6d39c4,0xba553a0e,0x3a35ba35,0x3a22ba46,0x3a0eba55,0x39f1ba62
.long 0x22773a80,0x1cb7ba80,0x23423a80,0xa304ba80,0xb9c4ba6d,0x39953a75,0xb948ba7b,0x38c93a7f,0x3a353a35,0xba0eba55,0x39c43a6d,0xb948ba7b,0xba6db9c4,0x3a463a22,0xba0eba55,0x39953a75
.long 0x3a8021d4,0xba6db9c4,0x3a353a35,0xb9c4ba6d,0xba6d39c4,0x3a7f38c9,0xba55ba0e,0x39f13a62,0x3a35ba35,0xba7b3948,0x3a6d39c4,0xba0eba55,0xb9c43a6d,0x3a62b9f1,0xba7bb948,0x3a223a46
.long 0xa30dba80,0xba353a35,0x3a80a2e5,0xba35ba35,0x39c43a6d,0x39f1ba62,0xba7b3948,0x3a463a22,0xba35ba35,0xb9483a7b,0x3a6db9c4,0xba55ba0e,0x3a6d39c4,0xb8c9ba7f,0xba553a0e,0x3a6239f1
.long 0xba80239a,0x39c43a6d,0x3a35ba35,0xba6db9c4,0x3a6db9c4,0xba22ba46,0xba0e3a55,0x3a753995,0xba353a35,0x3a553a0e,0x39c4ba6d,0xba7bb948,0x39c4ba6d,0xba75b995,0xb9483a7b,0x3a7f38c9
.long 0xa20d3a80,0x3a80a380,0xa20dba80,0xba8023a3,0xb9c4ba6d,0xba753995,0x39483a7b,0x3a7fb8c9,0x3a353a35,0x3a55ba0e,0xb9c4ba6d,0xba7b3948,0xba6db9c4,0xba223a46,0x3a0e3a55,0x3a75b995
.long 0x3a8023be,0x39c4ba6d,0xba35ba35,0xba6d39c4,0xba6d39c4,0xb8c93a7f,0x3a553a0e,0x3a62b9f1,0x3a35ba35,0xb948ba7b,0xba6db9c4,0xba553a0e,0xb9c43a6d,0x39f13a62,0x3a7b3948,0x3a46ba22
.long 0xa396ba80,0xba35ba35,0xba80a231,0xba353a35,0x39c43a6d,0x3a6239f1,0x3a7bb948,0x3a22ba46,0xba35ba35,0xba7bb948,0xba6d39c4,0xba0e3a55,0x3a6d39c4,0x3a7fb8c9,0x3a55ba0e,0x39f1ba62
.long 0xba8023ea,0xba6d39c4,0xba353a35,0xb9c43a6d,0x3a6db9c4,0x3a46ba22,0x3a0eba55,0x3995ba75,0xba353a35,0xba0e3a55,0xb9c43a6d,0xb9483a7b,0x39c4ba6d,0x3995ba75,0x3948ba7b,0x38c9ba7f
.p2align 8
TAB_K2:
.long 0x3f80,0x3f80,0x3f80,0x3f80,0x3f808000,0x3f808000,0x3f808000,0x3f808000,0x3f80,0x3ec43f6d,0x3f353f35,0x3f6d3ec4,0x3f808000,0x3f6dbec4,0x3f35bf35,0x3ec4bf6d
.long 0x3f80,0x3f353f35,0x3f80248d,0x3f35bf35,0x3f808000,0x3f35bf35,0x248dbf80,0xbf35bf35,0x3f80,0x3f6d3ec4,0x3f35bf35,0xbec4bf6d,0x3f808000,0x3ec4bf6d,0xbf35bf35,0xbf6d3ec4
.long 0x3f80,0x3f80248d,0x250dbf80,0xbf80a554,0x3f808000,0x248dbf80,0xbf80a50d,0xa5543f80,0x3f80,0x3f6dbec4,0xbf35bf35,0xbec43f6d,0x3f808000,0xbec4bf6d,0xbf353f35,0x3f6d3ec4
.long 0x3f80,0x3f35bf35,0xbf80a554,0x3f353f35,0x3f808000,0xbf35bf35,0xa5543f80,0x3f35bf35,0x3f80,0x3ec4bf6d,0xbf353f35,0x3f6dbec4,0x3f808000,0xbf6dbec4,0x3f353f35,0xbec4bf6d
.long 0x3f80,0x3f80,0x3f80,0x3f80,0x3f808000,0x3f808000,0x3f808000,0x3f808000,0x3f80248d,0x3f6dbec4,0x3f35bf35,0x3ec4bf6d,0x248dbf80,0xbec4bf6d,0xbf35bf35,0xbf6dbec4
.long 0x250dbf80,0xbf35bf35,0xbf80a554,0xbf353f35,0xbf80a50d,0xbf353f35,0xa5543f80,0x3f353f35,0xbf80a554,0xbec43f6d,0x3f353f35,0x3f6dbec4,0xa5543f80,0x3f6d3ec4,0x3f35bf35,0xbec4bf6d
.long 0xa58d3f80,0x3f8025b0,0x25d4bf80,0xbf80a5f7,0x3f80258d,0x25b0bf80,0xbf80a5d4,0xa5f73f80,0x3f8025b0,0xbec4bf6d,0xbf353f35,0x3f6d3ec4,0x25b0bf80,0xbf6d3ec4,0x3f353f35,0x3ec4bf6d
.long 0x25d4bf80,0xbf353f35,0x3f80261f,0xbf35bf35,0xbf80a5d4,0x3f353f35,0x261fbf80,0xbf353f35,0xbf80a5f7,0x3f6d3ec4,0xbf35bf35,0x3ec43f6d,0xa5f73f80,0x3ec4bf6d,0xbf353f35,0x3f6dbec4
.long 0x3f80,0x3f80,0x3f80,0x3f80,0x3f808000,0x3f808000,0x3f808000,0x3f808000,0x250dbf80,0xbec4bf6d,0xbf35bf35,0xbf6dbec4,0xbf80a50d,0xbf6d3ec4,0xbf353f35,0xbec43f6d
.long 0xa58d3f80,0x3f353f35,0x3f8025b0,0x3f35bf35,0x3f80258d,0x3f35bf35,0x25b0bf80,0xbf35bf35,0x25d4bf80,0xbf6dbec4,0xbf353f35,0x3ec43f6d,0xbf80a5d4,0xbec43f6d,0x3f353f35,0x3f6dbec4
.long 0xa60d3f80,0x3f80261f,0x2630bf80,0xbf80a731,0x3f80260d,0x261fbf80,0xbf80a630,0xa7313f80,0x2630bf80,0xbf6d3ec4,0x3f353f35,0x3ec4bf6d,0xbf80a630,0x3ec43f6d,0x3f35bf35,0xbf6dbec4
.long 0xa6543f80,0x3f35bf35,0xbf80a742,0x3f353f35,0x3f802654,0xbf35bf35,0xa7423f80,0x3f35bf35,0x2677bf80,0xbec43f6d,0x3f35bf35,0xbf6d3ec4,0xbf80a677,0x3f6d3ec4,0xbf35bf35,0x3ec43f6d
.long 0x3f80,0x3f80,0x3f80,0x3f80,0x3f808000,0x3f808000,0x3f808000,0x3f808000,0xbf80a554,0xbf6d3ec4,0xbf353f35,0xbec43f6d,0xa5543f80,0x3ec43f6d,0x3f353f35,0x3f6d3ec4
.long 0x25d4bf80,0xbf35bf35,0xbf80a5f7,0xbf353f35,0xbf80a5d4,0xbf353f35,0xa5f73f80,0x3f353f35,0x3f80261f,0x3ec4bf6d,0xbf35bf35,0xbf6d3ec4,0x261fbf80,0xbf6dbec4,0xbf353f35,0x3ec43f6d
.long 0xa6543f80,0x3f80a68d,0x2677bf80,0xbf80a742,0x3f802654,0xa68dbf80,0xbf80a677,0xa7423f80,0xbf80a742,0x3ec43f6d,0x3f35bf35,0xbf6dbec4,0xa7423f80,0x3f6dbec4,0xbf35bf35,0xbec43f6d
.long 0x269fbf80,0xbf353f35,0x3f80a60d,0xbf35bf35,0xbf80a69f,0x3f353f35,0xa60dbf80,0xbf353f35,0x3f80a60d,0xbf6dbec4,0x3f353f35,0xbec4bf6d,0xa60dbf80,0xbec43f6d,0x3f35bf35,0xbf6d3ec4
.long 0x3f80,0x250dbf80,0xa58d3f80,0x25d4bf80,0x3f808000,0xbf80a50d,0x3f80258d,0xbf80a5d4,0x3f80,0xbec4bf6d,0x3f353f35,0xbf6dbec4,0x3f808000,0xbf6d3ec4,0x3f35bf35,0xbec43f6d
.long 0x3f80,0xbf35bf35,0x3f8025b0,0xbf353f35,0x3f808000,0xbf353f35,0x25b0bf80,0x3f353f35,0x3f80,0xbf6dbec4,0x3f35bf35,0x3ec43f6d,0x3f808000,0xbec43f6d,0xbf35bf35,0x3f6dbec4
.long 0x3f80,0xbf80a554,0x25d4bf80,0x3f80261f,0x3f808000,0xa5543f80,0xbf80a5d4,0x261fbf80,0x3f80,0xbf6d3ec4,0xbf35bf35,0x3ec4bf6d,0x3f808000,0x3ec43f6d,0xbf353f35,0xbf6dbec4
.long 0x3f80,0xbf353f35,0xbf80a5f7,0xbf35bf35,0x3f808000,0x3f353f35,0xa5f73f80,0xbf353f35,0x3f80,0xbec43f6d,0xbf353f35,0xbf6d3ec4,0x3f808000,0x3f6d3ec4,0x3f353f35,0x3ec43f6d
.long 0xa60d3f80,0x2630bf80,0xa6543f80,0x2677bf80,0x3f80260d,0xbf80a630,0x3f802654,0xbf80a677,0x3f80261f,0xbf6d3ec4,0x3f35bf35,0xbec43f6d,0x261fbf80,0x3ec43f6d,0xbf35bf35,0x3f6d3ec4
.long 0x2630bf80,0x3f353f35,0xbf80a742,0x3f35bf35,0xbf80a630,0x3f35bf35,0xa7423f80,0xbf35bf35,0xbf80a731,0x3ec4bf6d,0x3f353f35,0xbf6d3ec4,0xa7313f80,0xbf6dbec4,0x3f35bf35,0x3ec43f6d
.long 0xa6543f80,0xbf80a742,0x269fbf80,0x3f80a60d,0x3f802654,0xa7423f80,0xbf80a69f,0xa60dbf80,0x3f80a68d,0x3ec43f6d,0xbf353f35,0xbf6dbec4,0xa68dbf80,0x3f6dbec4,0x3f353f35,0xbec43f6d
.long 0x2677bf80,0x3f35bf35,0x3f80a60d,0x3f353f35,0xbf80a677,0xbf35bf35,0xa60dbf80,0x3f35bf35,0xbf80a742,0xbf6dbec4,0xbf35bf35,0xbec4bf6d,0xa7423f80,0xbec43f6d,0xbf353f35,0xbf6d3ec4
.long 0xa68d3f80,0x269fbf80,0xa6b03f80,0x27b1bf80,0x3f80268d,0xbf80a69f,0x3f8026b0,0xbf80a7b1,0x269fbf80,0x3ec43f6d,0xbf35bf35,0x3f6d3ec4,0xbf80a69f,0x3f6dbec4,0xbf353f35,0x3ec4bf6d
.long 0xa6b03f80,0xbf35bf35,0x3f80a58e,0xbf353f35,0x3f8026b0,0xbf353f35,0xa58ebf80,0x3f353f35,0x27b1bf80,0x3f6d3ec4,0xbf353f35,0xbec4bf6d,0xbf80a7b1,0x3ec4bf6d,0x3f353f35,0xbf6d3ec4
.long 0xa6d43f80,0xbf80a777,0x27c2bf80,0x3f802804,0x3f8026d4,0xa7773f80,0xbf80a7c2,0x2804bf80,0xa70dbf80,0x3f6dbec4,0x3f353f35,0xbec43f6d,0xbf80270d,0xbec4bf6d,0x3f35bf35,0x3f6d3ec4
.long 0xa6f73f80,0xbf353f35,0xbf80a78d,0xbf35bf35,0x3f8026f7,0x3f353f35,0xa78d3f80,0xbf353f35,0x27c2bf80,0x3ec4bf6d,0x3f35bf35,0x3f6dbec4,0xbf80a7c2,0xbf6dbec4,0xbf35bf35,0xbec4bf6d
.long 0xa6d43f80,0xa70dbf80,0xa6f73f80,0x27c2bf80,0x3f8026d4,0xbf80270d,0x3f8026f7,0xbf80a7c2,0xbf80a777,0x3f6dbec4,0xbf353f35,0x3ec4bf6d,0xa7773f80,0xbec4bf6d,0x3f353f35,0xbf6dbec4
.long 0x27c2bf80,0x3f353f35,0xbf80a78d,0x3f35bf35,0xbf80a7c2,0x3f35bf35,0xa78d3f80,0xbf35bf35,0x3f80258d,0xbec43f6d,0xbf35bf35,0x3f6dbec4,0x258dbf80,0x3f6d3ec4,0xbf353f35,0xbec4bf6d
.long 0xa71f3f80,0xbf802754,0xa68dbf80,0x3f802889,0x3f80271f,0x27543f80,0xbf80268d,0x2889bf80,0xbf80a796,0xbec4bf6d,0x3f35bf35,0x3f6d3ec4,0xa7963f80,0xbf6d3ec4,0xbf35bf35,0x3ec4bf6d
.long 0xa68dbf80,0x3f35bf35,0x3f802816,0x3f353f35,0xbf80268d,0xbf35bf35,0x2816bf80,0x3f35bf35,0x3f80268d,0x3f6d3ec4,0x3f353f35,0x3ec43f6d,0x268dbf80,0x3ec4bf6d,0x3f35bf35,0x3f6dbec4
.long 0x3b00,0x3b00,0x3b00,0x3b00,0x3b00,0x3a443aed,0x3ab53ab5,0x3aed3a44,0x3b00,0x3ab53ab5,0x3b00200d,0x3ab5bab5,0x3b00,0x3aed3a44,0x3ab5bab5,0xba44baed
.long 0x3b00,0x3b00200d,0x208dbb00,0xbb00a0d4,0x3b00,0x3aedba44,0xbab5bab5,0xba443aed,0x3b00,0x3ab5bab5,0xbb00a0d4,0x3ab53ab5,0x3b00,0x3a44baed,0xbab53ab5,0x3aedba44
.long 0x3b00,0x208dbb00,0xa10d3b00,0x2154bb00,0x3b00,0xba44baed,0x3ab53ab5,0xbaedba44,0x3b00,0xbab5bab5,0x3b002130,0xbab53ab5,0x3b00,0xbaedba44,0x3ab5bab5,0x3a443aed
.long 0x3b00,0xbb00a0d4,0x2154bb00,0x3b00219f,0x3b00,0xbaed3a44,0xbab5bab5,0x3a44baed,0x3b00,0xbab53ab5,0xbb00a177,0xbab5bab5,0x3b00,0xba443aed,0xbab53ab5,0xbaed3a44
.long 0xbb000000,0xbb000000,0xbb000000,0xbb000000,0xbb000000,0xbaed3a44,0xbab53ab5,0xba443aed,0xbb000000,0xbab53ab5,0xa00d3b00,0x3ab53ab5,0xbb000000,0xba443aed,0x3ab53ab5,0x3aedba44
.long 0xbb000000,0xa00d3b00,0x3b00208d,0x20d4bb00,0xbb000000,0x3a443aed,0x3ab5bab5,0xbaedba44,0xbb000000,0x3ab53ab5,0x20d4bb00,0xbab53ab5,0xbb000000,0x3aed3a44,0xbab5bab5,0x3a443aed
.long 0xbb000000,0x3b00208d,0xbb00a10d,0x3b002154,0xbb000000,0x3aedba44,0xbab53ab5,0x3a44baed,0xbb000000,0x3ab5bab5,0xa1303b00,0xbab5bab5,0xbb000000,0x3a44baed,0x3ab53ab5,0xbaed3a44
.long 0xbb000000,0x20d4bb00,0x3b002154,0xa19f3b00,0xbb000000,0xba44baed,0x3ab5bab5,0x3aed3a44,0xbb000000,0xbab5bab5,0x2177bb00,0x3ab5bab5,0xbb000000,0xbaedba44,0xbab5bab5,0xba44baed
.long 0x3b00,0x3b00,0x3b00,0x3b00,0x3b00200d,0x3aedba44,0x3ab5bab5,0x3a44baed,0x208dbb00,0xbab5bab5,0xbb00a0d4,0xbab53ab5,0xbb00a0d4,0xba443aed,0x3ab53ab5,0x3aedba44
.long 0xa10d3b00,0x3b002130,0x2154bb00,0xbb00a177,0x3b002130,0xba44baed,0xbab53ab5,0x3aed3a44,0x2154bb00,0xbab53ab5,0x3b00219f,0xbab5bab5,0xbb00a177,0x3aed3a44,0xbab5bab5,0x3a443aed
.long 0xa18d3b00,0x21b0bb00,0xa1d43b00,0x21f7bb00,0x3b00219f,0xbaed3a44,0x3ab5bab5,0xba443aed,0x21b0bb00,0x3ab53ab5,0xbb00a2c2,0x3ab5bab5,0xbb00a2b1,0x3a44baed,0x3ab53ab5,0xbaed3a44
.long 0xa1d43b00,0xbb00a2c2,0x221fbb00,0x3b00a18d,0x3b00a20d,0x3a443aed,0xbab53ab5,0xbaedba44,0x21f7bb00,0x3ab5bab5,0x3b00a18d,0x3ab53ab5,0xbb00a2c2,0xbaedba44,0xbab5bab5,0xba44baed
.long 0xbb000000,0xbb000000,0xbb000000,0xbb000000,0xa00d3b00,0x3a443aed,0x3ab53ab5,0x3aed3a44,0x3b00208d,0x3ab5bab5,0x20d4bb00,0xbab5bab5,0x20d4bb00,0xbaedba44,0xbab53ab5,0x3a443aed
.long 0xbb00a10d,0xa1303b00,0x3b002154,0x2177bb00,0xa1303b00,0x3aedba44,0xbab5bab5,0xba443aed,0x3b002154,0xbab5bab5,0xa19f3b00,0x3ab5bab5,0x2177bb00,0xba443aed,0x3ab5bab5,0xbaed3a44
.long 0xbb00a18d,0x3b0021b0,0xbb00a1d4,0x3b0021f7,0xa19f3b00,0xba44baed,0x3ab53ab5,0xbaedba44,0x3b0021b0,0xbab53ab5,0x22c2bb00,0x3ab53ab5,0x22b1bb00,0x3aed3a44,0xbab53ab5,0xba44baed
.long 0xbb00a1d4,0x22c2bb00,0x3b00221f,0x218d3b00,0x220d3b00,0xbaed3a44,0xbab5bab5,0x3a44baed,0x3b0021f7,0x3ab53ab5,0x218d3b00,0xbab53ab5,0x22c2bb00,0x3a44baed,0x3ab5bab5,0x3aedba44
.long 0x3b00,0x3b00,0x3b00,0x3b00,0x208dbb00,0xba44baed,0xbab5bab5,0xbaedba44,0xa10d3b00,0x3ab53ab5,0x3b002130,0x3ab5bab5,0x2154bb00,0xbaedba44,0xbab53ab5,0x3a443aed
.long 0xa18d3b00,0x3b00219f,0x21b0bb00,0xbb00a2b1,0x21b0bb00,0xbaed3a44,0x3ab53ab5,0x3a44baed,0xa1d43b00,0x3ab5bab5,0xbb00a2c2,0x3ab53ab5,0x21f7bb00,0xba443aed,0x3ab5bab5,0xbaed3a44
.long 0xa20d3b00,0x221fbb00,0xa2303b00,0x2331bb00,0x221fbb00,0x3a443aed,0xbab5bab5,0x3aed3a44,0xa2303b00,0xbab5bab5,0x3b00a10e,0xbab53ab5,0x2331bb00,0x3aed3a44,0xbab53ab5,0xba44baed
.long 0xa2543b00,0xbb00a2f7,0x2342bb00,0x3b00210d,0xa28dbb00,0x3aedba44,0x3ab53ab5,0xba443aed,0xa2773b00,0xbab53ab5,0xbb00a30d,0xbab5bab5,0x2342bb00,0x3a44baed,0x3ab5bab5,0x3aedba44
.long 0xbb000000,0xbb000000,0xbb000000,0xbb000000,0x3b00208d,0x3aedba44,0x3ab5bab5,0x3a44baed,0xbb00a10d,0xbab53ab5,0xa1303b00,0x3ab53ab5,0x3b002154,0x3a44baed,0xbab5bab5,0xbaed3a44
.long 0xbb00a18d,0xa19f3b00,0x3b0021b0,0x22b1bb00,0x3b0021b0,0xba44baed,0xbab53ab5,0x3aed3a44,0xbb00a1d4,0x3ab53ab5,0x22c2bb00,0xbab53ab5,0x3b0021f7,0xbaedba44,0x3ab53ab5,0xba44baed
.long 0xbb00a20d,0x3b00221f,0xbb00a230,0x3b002331,0x3b00221f,0xbaed3a44,0x3ab5bab5,0xba443aed,0xbb00a230,0x3ab5bab5,0x210e3b00,0xbab5bab5,0x3b002331,0xba443aed,0xbab5bab5,0x3aedba44
.long 0xbb00a254,0x22f7bb00,0x3b002342,0xa10d3b00,0x3b00a28d,0x3a443aed,0xbab53ab5,0xbaedba44,0xbb00a277,0xbab5bab5,0x230dbb00,0x3ab5bab5,0x3b002342,0x3aed3a44,0x3ab53ab5,0x3a443aed
.long 0x3b00,0x3b00,0x3b00,0x3b00,0xbb00a0d4,0xbaed3a44,0xbab53ab5,0xba443aed,0x2154bb00,0xbab5bab5,0xbb00a177,0xbab53ab5,0x3b00219f,0x3a44baed,0xbab5bab5,0xbaed3a44
.long 0xa1d43b00,0x3b00a20d,0x21f7bb00,0xbb00a2c2,0xbb00a2c2,0x3a443aed,0x3ab5bab5,0xbaedba44,0x221fbb00,0xbab53ab5,0x3b00a18d,0xbab5bab5,0x3b00a18d,0xbaedba44,0x3ab53ab5,0xba44baed
.long 0xa2543b00,0xa28dbb00,0xa2773b00,0x2342bb00,0xbb00a2f7,0x3aedba44,0xbab53ab5,0x3a44baed,0x2342bb00,0x3ab53ab5,0xbb00a30d,0x3ab5bab5,0x3b002384,0xba443aed,0xbab5bab5,0x3aedba44
.long 0xa29f3b00,0xbb00a316,0xa20dbb00,0x3b00220d,0xbb0022d4,0xba44baed,0x3ab5bab5,0x3aed3a44,0xa20dbb00,0x3ab5bab5,0x3b002396,0x3ab53ab5,0x3b002409,0x3aed3a44,0x3ab53ab5,0x3a443aed
.long 0xbb000000,0xbb000000,0xbb000000,0xbb000000,0x20d4bb00,0xba44baed,0xbab5bab5,0xbaedba44,0x3b002154,0x3ab5bab5,0x2177bb00,0xbab5bab5,0xa19f3b00,0x3aed3a44,0x3ab5bab5,0xba44baed
.long 0xbb00a1d4,0x220d3b00,0x3b0021f7,0x22c2bb00,0x22c2bb00,0xbaed3a44,0x3ab53ab5,0x3a44baed,0x3b00221f,0xbab5bab5,0x218d3b00,0x3ab5bab5,0x218d3b00,0x3a44baed,0xbab53ab5,0x3aedba44
.long 0xbb00a254,0x3b00a28d,0xbb00a277,0x3b002342,0x22f7bb00,0x3a443aed,0xbab5bab5,0x3aed3a44,0x3b002342,0xbab53ab5,0x230dbb00,0x3ab53ab5,0xa3843b00,0xbaedba44,0x3ab5bab5,0x3a443aed
.long 0xbb00a29f,0x2316bb00,0x3b00a20d,0xa20d3b00,0xa2d4bb00,0x3aedba44,0x3ab53ab5,0xba443aed,0x3b00a20d,0x3ab53ab5,0xa3963b00,0xbab53ab5,0xa4093b00,0xba443aed,0xbab53ab5,0xbaed3a44
.long 0x3f80,0x3f80,0x3f80,0x3f80,0x3f808000,0x3f808000,0x3f808000,0x3f808000,0x3f80,0x3ec43f6d,0x3f353f35,0x3f6d3ec4,0x3f808000,0x3f6dbec4,0x3f35bf35,0x3ec4bf6d
.long 0x3f80,0x3f353f35,0x3f80248d,0x3f35bf35,0x3f808000,0x3f35bf35,0x248dbf80,0xbf35bf35,0x3f80,0x3f6d3ec4,0x3f35bf35,0xbec4bf6d,0x3f808000,0x3ec4bf6d,0xbf35bf35,0xbf6d3ec4
.long 0x3f80,0x3f80248d,0x250dbf80,0xbf80a554,0x3f808000,0x248dbf80,0xbf80a50d,0xa5543f80,0x3f80,0x3f6dbec4,0xbf35bf35,0xbec43f6d,0x3f808000,0xbec4bf6d,0xbf353f35,0x3f6d3ec4
.long 0x3f80,0x3f35bf35,0xbf80a554,0x3f353f35,0x3f808000,0xbf35bf35,0xa5543f80,0x3f35bf35,0x3f80,0x3ec4bf6d,0xbf353f35,0x3f6dbec4,0x3f808000,0xbf6dbec4,0x3f353f35,0xbec4bf6d
.long 0x3f80,0x3f80,0x3f80,0x3f80,0x3f808000,0x3f808000,0x3f808000,0x3f808000,0x3f80248d,0x3f6dbec4,0x3f35bf35,0x3ec4bf6d,0x248dbf80,0xbec4bf6d,0xbf35bf35,0xbf6dbec4
.long 0x250dbf80,0xbf35bf35,0xbf80a554,0xbf353f35,0xbf80a50d,0xbf353f35,0xa5543f80,0x3f353f35,0xbf80a554,0xbec43f6d,0x3f353f35,0x3f6dbec4,0xa5543f80,0x3f6d3ec4,0x3f35bf35,0xbec4bf6d
.long 0xa58d3f80,0x3f8025b0,0x25d4bf80,0xbf80a5f7,0x3f80258d,0x25b0bf80,0xbf80a5d4,0xa5f73f80,0x3f8025b0,0xbec4bf6d,0xbf353f35,0x3f6d3ec4,0x25b0bf80,0xbf6d3ec4,0x3f353f35,0x3ec4bf6d
.long 0x25d4bf80,0xbf353f35,0x3f80261f,0xbf35bf35,0xbf80a5d4,0x3f353f35,0x261fbf80,0xbf353f35,0xbf80a5f7,0x3f6d3ec4,0xbf35bf35,0x3ec43f6d,0xa5f73f80,0x3ec4bf6d,0xbf353f35,0x3f6dbec4
.long 0x3f80,0x3f80,0x3f80,0x3f80,0x3f808000,0x3f808000,0x3f808000,0x3f808000,0x250dbf80,0xbec4bf6d,0xbf35bf35,0xbf6dbec4,0xbf80a50d,0xbf6d3ec4,0xbf353f35,0xbec43f6d
.long 0xa58d3f80,0x3f353f35,0x3f8025b0,0x3f35bf35,0x3f80258d,0x3f35bf35,0x25b0bf80,0xbf35bf35,0x25d4bf80,0xbf6dbec4,0xbf353f35,0x3ec43f6d,0xbf80a5d4,0xbec43f6d,0x3f353f35,0x3f6dbec4
.long 0xa60d3f80,0x3f80261f,0x2630bf80,0xbf80a731,0x3f80260d,0x261fbf80,0xbf80a630,0xa7313f80,0x2630bf80,0xbf6d3ec4,0x3f353f35,0x3ec4bf6d,0xbf80a630,0x3ec43f6d,0x3f35bf35,0xbf6dbec4
.long 0xa6543f80,0x3f35bf35,0xbf80a742,0x3f353f35,0x3f802654,0xbf35bf35,0xa7423f80,0x3f35bf35,0x2677bf80,0xbec43f6d,0x3f35bf35,0xbf6d3ec4,0xbf80a677,0x3f6d3ec4,0xbf35bf35,0x3ec43f6d
.long 0x3f80,0x3f80,0x3f80,0x3f80,0x3f808000,0x3f808000,0x3f808000,0x3f808000,0xbf80a554,0xbf6d3ec4,0xbf353f35,0xbec43f6d,0xa5543f80,0x3ec43f6d,0x3f353f35,0x3f6d3ec4
.long 0x25d4bf80,0xbf35bf35,0xbf80a5f7,0xbf353f35,0xbf80a5d4,0xbf353f35,0xa5f73f80,0x3f353f35,0x3f80261f,0x3ec4bf6d,0xbf35bf35,0xbf6d3ec4,0x261fbf80,0xbf6dbec4,0xbf353f35,0x3ec43f6d
.long 0xa6543f80,0x3f80a68d,0x2677bf80,0xbf80a742,0x3f802654,0xa68dbf80,0xbf80a677,0xa7423f80,0xbf80a742,0x3ec43f6d,0x3f35bf35,0xbf6dbec4,0xa7423f80,0x3f6dbec4,0xbf35bf35,0xbec43f6d
.long 0x269fbf80,0xbf353f35,0x3f80a60d,0xbf35bf35,0xbf80a69f,0x3f353f35,0xa60dbf80,0xbf353f35,0x3f80a60d,0xbf6dbec4,0x3f353f35,0xbec4bf6d,0xa60dbf80,0xbec43f6d,0x3f35bf35,0xbf6d3ec4
.long 0x3f80,0x250dbf80,0xa58d3f80,0x25d4bf80,0x3f808000,0xbf80a50d,0x3f80258d,0xbf80a5d4,0x3f80,0xbec4bf6d,0x3f353f35,0xbf6dbec4,0x3f808000,0xbf6d3ec4,0x3f35bf35,0xbec43f6d
.long 0x3f80,0xbf35bf35,0x3f8025b0,0xbf353f35,0x3f808000,0xbf353f35,0x25b0bf80,0x3f353f35,0x3f80,0xbf6dbec4,0x3f35bf35,0x3ec43f6d,0x3f808000,0xbec43f6d,0xbf35bf35,0x3f6dbec4
.long 0x3f80,0xbf80a554,0x25d4bf80,0x3f80261f,0x3f808000,0xa5543f80,0xbf80a5d4,0x261fbf80,0x3f80,0xbf6d3ec4,0xbf35bf35,0x3ec4bf6d,0x3f808000,0x3ec43f6d,0xbf353f35,0xbf6dbec4
.long 0x3f80,0xbf353f35,0xbf80a5f7,0xbf35bf35,0x3f808000,0x3f353f35,0xa5f73f80,0xbf353f35,0x3f80,0xbec43f6d,0xbf353f35,0xbf6d3ec4,0x3f808000,0x3f6d3ec4,0x3f353f35,0x3ec43f6d
.long 0xa60d3f80,0x2630bf80,0xa6543f80,0x2677bf80,0x3f80260d,0xbf80a630,0x3f802654,0xbf80a677,0x3f80261f,0xbf6d3ec4,0x3f35bf35,0xbec43f6d,0x261fbf80,0x3ec43f6d,0xbf35bf35,0x3f6d3ec4
.long 0x2630bf80,0x3f353f35,0xbf80a742,0x3f35bf35,0xbf80a630,0x3f35bf35,0xa7423f80,0xbf35bf35,0xbf80a731,0x3ec4bf6d,0x3f353f35,0xbf6d3ec4,0xa7313f80,0xbf6dbec4,0x3f35bf35,0x3ec43f6d
.long 0xa6543f80,0xbf80a742,0x269fbf80,0x3f80a60d,0x3f802654,0xa7423f80,0xbf80a69f,0xa60dbf80,0x3f80a68d,0x3ec43f6d,0xbf353f35,0xbf6dbec4,0xa68dbf80,0x3f6dbec4,0x3f353f35,0xbec43f6d
.long 0x2677bf80,0x3f35bf35,0x3f80a60d,0x3f353f35,0xbf80a677,0xbf35bf35,0xa60dbf80,0x3f35bf35,0xbf80a742,0xbf6dbec4,0xbf35bf35,0xbec4bf6d,0xa7423f80,0xbec43f6d,0xbf353f35,0xbf6d3ec4
.long 0xa68d3f80,0x269fbf80,0xa6b03f80,0x27b1bf80,0x3f80268d,0xbf80a69f,0x3f8026b0,0xbf80a7b1,0x269fbf80,0x3ec43f6d,0xbf35bf35,0x3f6d3ec4,0xbf80a69f,0x3f6dbec4,0xbf353f35,0x3ec4bf6d
.long 0xa6b03f80,0xbf35bf35,0x3f80a58e,0xbf353f35,0x3f8026b0,0xbf353f35,0xa58ebf80,0x3f353f35,0x27b1bf80,0x3f6d3ec4,0xbf353f35,0xbec4bf6d,0xbf80a7b1,0x3ec4bf6d,0x3f353f35,0xbf6d3ec4
.long 0xa6d43f80,0xbf80a777,0x27c2bf80,0x3f802804,0x3f8026d4,0xa7773f80,0xbf80a7c2,0x2804bf80,0xa70dbf80,0x3f6dbec4,0x3f353f35,0xbec43f6d,0xbf80270d,0xbec4bf6d,0x3f35bf35,0x3f6d3ec4
.long 0xa6f73f80,0xbf353f35,0xbf80a78d,0xbf35bf35,0x3f8026f7,0x3f353f35,0xa78d3f80,0xbf353f35,0x27c2bf80,0x3ec4bf6d,0x3f35bf35,0x3f6dbec4,0xbf80a7c2,0xbf6dbec4,0xbf35bf35,0xbec4bf6d
.long 0xa6d43f80,0xa70dbf80,0xa6f73f80,0x27c2bf80,0x3f8026d4,0xbf80270d,0x3f8026f7,0xbf80a7c2,0xbf80a777,0x3f6dbec4,0xbf353f35,0x3ec4bf6d,0xa7773f80,0xbec4bf6d,0x3f353f35,0xbf6dbec4
.long 0x27c2bf80,0x3f353f35,0xbf80a78d,0x3f35bf35,0xbf80a7c2,0x3f35bf35,0xa78d3f80,0xbf35bf35,0x3f80258d,0xbec43f6d,0xbf35bf35,0x3f6dbec4,0x258dbf80,0x3f6d3ec4,0xbf353f35,0xbec4bf6d
.long 0xa71f3f80,0xbf802754,0xa68dbf80,0x3f802889,0x3f80271f,0x27543f80,0xbf80268d,0x2889bf80,0xbf80a796,0xbec4bf6d,0x3f35bf35,0x3f6d3ec4,0xa7963f80,0xbf6d3ec4,0xbf35bf35,0x3ec4bf6d
.long 0xa68dbf80,0x3f35bf35,0x3f802816,0x3f353f35,0xbf80268d,0xbf35bf35,0x2816bf80,0x3f35bf35,0x3f80268d,0x3f6d3ec4,0x3f353f35,0x3ec43f6d,0x268dbf80,0x3ec4bf6d,0x3f35bf35,0x3f6dbec4
.long 0x3b00,0x3b00,0x3b00,0x3b00,0x39c83afb,0x3a8e3ad5,0x3ad53a8e,0x3afb39c8,0x3a443aed,0x3aed3a44,0x3aedba44,0x3a44baed,0x3a8e3ad5,0x3afbb9c8,0x39c8bafb,0xbad5ba8e
.long 0x3ab53ab5,0x3ab5bab5,0xbab5bab5,0xbab53ab5,0x3ad53a8e,0x39c8bafb,0xbafb39c8,0x3a8e3ad5,0x3aed3a44,0xba44baed,0xba443aed,0x3aedba44,0x3afb39c8,0xbad5ba8e,0x3a8e3ad5,0xb9c8bafb
.long 0x3b00200d,0xbb00a0d4,0x3b002130,0xbb00a177,0x3afbb9c8,0xbad53a8e,0x3a8ebad5,0xb9c83afb,0x3aedba44,0xba443aed,0xba44baed,0x3aed3a44,0x3ad5ba8e,0x39c83afb,0xbafbb9c8,0x3a8ebad5
.long 0x3ab5bab5,0x3ab53ab5,0xbab53ab5,0xbab5bab5,0x3a8ebad5,0x3afb39c8,0x39c83afb,0xbad53a8e,0x3a44baed,0x3aedba44,0x3aed3a44,0x3a443aed,0x39c8bafb,0x3a8ebad5,0x3ad5ba8e,0x3afbb9c8
.long 0xbb000000,0xbb000000,0xbb000000,0xbb000000,0xbafb39c8,0xbad53a8e,0xba8e3ad5,0xb9c83afb,0xbaed3a44,0xba443aed,0x3a443aed,0x3aed3a44,0xbad53a8e,0x39c83afb,0x3afb39c8,0x3a8ebad5
.long 0xbab53ab5,0x3ab53ab5,0x3ab5bab5,0xbab5bab5,0xba8e3ad5,0x3afb39c8,0xb9c8bafb,0xbad53a8e,0xba443aed,0x3aedba44,0xbaedba44,0x3a443aed,0xb9c83afb,0x3a8ebad5,0xbad53a8e,0x3afbb9c8
.long 0xa00d3b00,0x20d4bb00,0xa1303b00,0x2177bb00,0x39c83afb,0xba8ebad5,0x3ad53a8e,0xbafbb9c8,0x3a443aed,0xbaedba44,0x3aedba44,0xba443aed,0x3a8e3ad5,0xbafb39c8,0x39c8bafb,0x3ad53a8e
.long 0x3ab53ab5,0xbab53ab5,0xbab5bab5,0x3ab5bab5,0x3ad53a8e,0xb9c83afb,0xbafb39c8,0xba8ebad5,0x3aed3a44,0x3a443aed,0xba443aed,0xbaed3a44,0x3afb39c8,0x3ad53a8e,0x3a8e3ad5,0x39c83afb
.long 0x3b00,0x3b00,0x3b00,0x3b00,0x3afbb9c8,0x3ad5ba8e,0x3a8ebad5,0x39c8bafb,0xba44baed,0xbaedba44,0xbaed3a44,0xba443aed,0xbad53a8e,0x39c83afb,0x3afb39c8,0x3a8ebad5
.long 0x3ab53ab5,0x3ab5bab5,0xbab5bab5,0xbab53ab5,0x3a8ebad5,0xbafbb9c8,0x39c83afb,0x3ad5ba8e,0xbaedba44,0x3a443aed,0x3a44baed,0xbaed3a44,0xb9c83afb,0x3a8ebad5,0xbad53a8e,0x3afbb9c8
.long 0x3b00219f,0xbb00a2b1,0x3b00a20d,0xbb00a2c2,0xb9c8bafb,0x3a8e3ad5,0xbad5ba8e,0x3afb39c8,0xbaed3a44,0x3a44baed,0x3a443aed,0xbaedba44,0x3a8e3ad5,0xbafb39c8,0x39c8bafb,0x3ad53a8e
.long 0x3ab5bab5,0x3ab53ab5,0xbab53ab5,0xbab5bab5,0xbad5ba8e,0x39c8bafb,0x3afbb9c8,0x3a8e3ad5,0xba443aed,0xbaed3a44,0xbaedba44,0xba44baed,0x3afb39c8,0x3ad53a8e,0x3a8e3ad5,0x39c83afb
.long 0xbb000000,0xbb000000,0xbb000000,0xbb000000,0x39c83afb,0x3a8e3ad5,0x3ad53a8e,0x3afb39c8,0x3aedba44,0x3a44baed,0xba44baed,0xbaedba44,0xba8ebad5,0xbafb39c8,0xb9c83afb,0x3ad53a8e
.long 0xbab53ab5,0x3ab53ab5,0x3ab5bab5,0xbab5bab5,0x3ad53a8e,0x39c8bafb,0xbafb39c8,0x3a8e3ad5,0x3a44baed,0xbaed3a44,0x3aed3a44,0xba44baed,0xbafbb9c8,0x3ad53a8e,0xba8ebad5,0x39c83afb
.long 0xa19f3b00,0x22b1bb00,0x220d3b00,0x22c2bb00,0x3afbb9c8,0xbad53a8e,0x3a8ebad5,0xb9c83afb,0xba44baed,0x3aed3a44,0xbaed3a44,0x3a44baed,0xbad53a8e,0xb9c8bafb,0x3afb39c8,0xba8e3ad5
.long 0x3ab53ab5,0xbab53ab5,0xbab5bab5,0x3ab5bab5,0x3a8ebad5,0x3afb39c8,0x39c83afb,0xbad53a8e,0xbaedba44,0xba44baed,0x3a44baed,0x3aedba44,0xb9c83afb,0xba8e3ad5,0xbad53a8e,0xbafb39c8
.long 0x3b00,0x3b00,0x3b00,0x3b00,0xb9c8bafb,0xba8ebad5,0xbad5ba8e,0xbafbb9c8,0x3a443aed,0x3aed3a44,0x3aedba44,0x3a44baed,0xba8ebad5,0xbafb39c8,0xb9c83afb,0x3ad53a8e
.long 0x3ab53ab5,0x3ab5bab5,0xbab5bab5,0xbab53ab5,0xbad5ba8e,0xb9c83afb,0x3afbb9c8,0xba8ebad5,0x3aed3a44,0xba44baed,0xba443aed,0x3aedba44,0xbafbb9c8,0x3ad53a8e,0xba8ebad5,0x39c83afb
.long 0x3b00a1d4,0xbb00a2d4,0x3b00a18d,0xbb00a2e5,0xbafb39c8,0x3ad5ba8e,0xba8e3ad5,0x39c8bafb,0x3aedba44,0xba443aed,0xba44baed,0x3aed3a44,0xbad53a8e,0xb9c8bafb,0x3afb39c8,0xba8e3ad5
.long 0x3ab5bab5,0x3ab53ab5,0xbab53ab5,0xbab5bab5,0xba8e3ad5,0xbafbb9c8,0xb9c8bafb,0x3ad5ba8e,0x3a44baed,0x3aedba44,0x3aed3a44,0x3a443aed,0xb9c83afb,0xba8e3ad5,0xbad53a8e,0xbafb39c8
.long 0xbb000000,0xbb000000,0xbb000000,0xbb000000,0x3afbb9c8,0x3ad5ba8e,0x3a8ebad5,0x39c8bafb,0xbaed3a44,0xba443aed,0x3a443aed,0x3aed3a44,0x3ad5ba8e,0xb9c8bafb,0xbafbb9c8,0xba8e3ad5
.long 0xbab53ab5,0x3ab53ab5,0x3ab5bab5,0xbab5bab5,0x3a8ebad5,0xbafbb9c8,0x39c83afb,0x3ad5ba8e,0xba443aed,0x3aedba44,0xbaedba44,0x3a443aed,0x39c8bafb,0xba8e3ad5,0x3ad5ba8e,0xbafb39c8
.long 0x21d43b00,0x22d4bb00,0x218d3b00,0x22e5bb00,0xb9c8bafb,0x3a8e3ad5,0xbad5ba8e,0x3afb39c8,0x3a443aed,0xbaedba44,0x3aedba44,0xba443aed,0xba8ebad5,0x3afbb9c8,0xb9c83afb,0xbad5ba8e
.long 0x3ab53ab5,0xbab53ab5,0xbab5bab5,0x3ab5bab5,0xbad5ba8e,0x39c8bafb,0x3afbb9c8,0x3a8e3ad5,0x3aed3a44,0x3a443aed,0xba443aed,0xbaed3a44,0xbafbb9c8,0xbad5ba8e,0xba8ebad5,0xb9c8bafb
.long 0x3b00,0x3b00,0x3b00,0x3b00,0xbafb39c8,0xbad53a8e,0xba8e3ad5,0xb9c83afb,0xba44baed,0xbaedba44,0xbaed3a44,0xba443aed,0x3ad5ba8e,0xb9c8bafb,0xbafbb9c8,0xba8e3ad5
.long 0x3ab53ab5,0x3ab5bab5,0xbab5bab5,0xbab53ab5,0xba8e3ad5,0x3afb39c8,0xb9c8bafb,0xbad53a8e,0xbaedba44,0x3a443aed,0x3a44baed,0xbaed3a44,0x39c8bafb,0xba8e3ad5,0x3ad5ba8e,0xbafb39c8
.long 0x3b00a10e,0xbb00a2f7,0x3b009cb7,0xbb00a304,0x39c83afb,0xba8ebad5,0x3ad53a8e,0xbafbb9c8,0xbaed3a44,0x3a44baed,0x3a443aed,0xbaedba44,0xba8ebad5,0x3afbb9c8,0xb9c83afb,0xbad5ba8e
.long 0x3ab5bab5,0x3ab53ab5,0xbab53ab5,0xbab5bab5,0x3ad53a8e,0xb9c83afb,0xbafb39c8,0xba8ebad5,0xba443aed,0xbaed3a44,0xbaedba44,0xba44baed,0xbafbb9c8,0xbad5ba8e,0xba8ebad5,0xb9c8bafb
.long 0xbb000000,0xbb000000,0xbb000000,0xbb000000,0xb9c8bafb,0xba8ebad5,0xbad5ba8e,0xbafbb9c8,0x3aedba44,0x3a44baed,0xba44baed,0xbaedba44,0x3a8e3ad5,0x3afbb9c8,0x39c8bafb,0xbad5ba8e
.long 0xbab53ab5,0x3ab53ab5,0x3ab5bab5,0xbab5bab5,0xbad5ba8e,0xb9c83afb,0x3afbb9c8,0xba8ebad5,0x3a44baed,0xbaed3a44,0x3aed3a44,0xba44baed,0x3afb39c8,0xbad5ba8e,0x3a8e3ad5,0xb9c8bafb
.long 0x210e3b00,0x22f7bb00,0x1cb73b00,0x2304bb00,0xbafb39c8,0x3ad5ba8e,0xba8e3ad5,0x39c8bafb,0xba44baed,0x3aed3a44,0xbaed3a44,0x3a44baed,0x3ad5ba8e,0x39c83afb,0xbafbb9c8,0x3a8ebad5
.long 0x3ab53ab5,0xbab53ab5,0xbab5bab5,0x3ab5bab5,0xba8e3ad5,0xbafbb9c8,0xb9c8bafb,0x3ad5ba8e,0xbaedba44,0xba44baed,0x3a44baed,0x3aedba44,0x39c8bafb,0x3a8ebad5,0x3ad5ba8e,0x3afbb9c8
```
